```python
import torch

def _softmax(x, axis=-1):
    return torch.softmax(x, dim=axis)
def _gelu(x):
    return torch.nn.functional.gelu(x, approximate="tanh")
def _silu(x):
    return torch.nn.functional.silu(x)
def _sigmoid(x):
    return torch.sigmoid(x)
def _layernorm(x, axis=-1, eps=1e-5):
    m = x.mean(dim=axis, keepdim=True)
    v = x.var(dim=axis, keepdim=True, unbiased=False)
    return (x - m) / torch.sqrt(v + eps)
def _scatter_add(tgt, idx, src, axis=0):
    return tgt.clone().index_add_(axis, idx, src)
def _segment_sum(src, seg, n):
    out = torch.zeros((n,) + src.shape[1:], dtype=src.dtype)
    return out.index_add_(0, seg, src)
def _pad(x, pw):
    flat = tuple(v for pair in reversed(pw) for v in pair)
    return torch.nn.functional.pad(x, flat)

kernel_name = 'standalone__mixer_s_mlp__sampling'

def setup_inputs():

    _w = (lambda a: (lambda t: t.to(torch.bfloat16) if t.is_floating_point() else t)(torch.as_tensor(a)))
    B, S, D, F = 16, 32, 576, 4608
    return {
        "x":  _w((lambda *s: torch.randn(*s, dtype=torch.bfloat16) * 0.4)(B, S, D)),
        "w1": _w((lambda *s: torch.randn(*s, dtype=torch.bfloat16) * 3.2)(D, D) * (D ** -0.5)),
        "w2": _w((lambda *s: torch.randn(*s, dtype=torch.bfloat16) * 3.2)(D, D) * (D ** -0.5)),
        "w3": _w((lambda *s: torch.randn(*s, dtype=torch.bfloat16) * 3.2)(D, F) * (D ** -0.5)),
        "w4": _w((lambda *s: torch.randn(*s, dtype=torch.bfloat16) * 0.8)(F, D) * (F ** -0.5)),
    }

def reference(x, w1, w2, w3, w4):
    B, S, D = x.shape
    h = _gelu(_layernorm(x, axis=-1) @ w1)
    c = D // 4
    g0 = _pad(h[:, :, 0*c:1*c], ((0, 0), (1, 0), (0, 0)))[:, :S, :]
    g1 = _pad(h[:, :, 1*c:2*c], ((0, 0), (0, 1), (0, 0)))[:, 1:, :]
    g2 = _pad(h[:, :, 2*c:3*c], ((0, 0), (2, 0), (0, 0)))[:, :S, :]
    g3 = _pad(h[:, :, 3*c:   ], ((0, 0), (0, 2), (0, 0)))[:, 2:, :]
    hs = torch.concatenate([g0, g1, g2, g3], axis=-1) @ w2
    x1 = x + hs
    h2 = _gelu(_layernorm(x1, axis=-1) @ w3) @ w4
    return x1 + h2
```

```asm
; @launch grid=(256,1,1) block=(256,1,1) lds=163840
.amdgcn_target "amdgcn-amd-amdhsa--gfx950"
.text
.globl standalone__mixer_s_mlp__sampling_kernel
.p2align 8
.type standalone__mixer_s_mlp__sampling_kernel,@function
standalone__mixer_s_mlp__sampling_kernel:

s_cmp_ge_u32 s2, 256
s_cbranch_scc1 L_end
s_load_dwordx16 s[4:19], s[0:1], 0
s_getpc_b64 s[66:67]
s_lshr_b32 s45, s2, 3
v_lshrrev_b32 v54, 6, v0
v_and_b32 v1, 63, v0
v_readfirstlane_b32 s48, v54
v_min_u32 v52, 9, v0
v_lshlrev_b32 v52, 5, v52
v_add_lshl_u32 v52, v52, s45, 7
global_load_dword v53, v52, s[66:67]
s_and_b32 s44, s2, 7
s_lshl_b32 s70, s48, 10
v_lshlrev_b32 v241, 7, v1
s_cmp_lt_u32 s45, 9
s_cbranch_scc1 L_p1
v_and_b32 v59, 15, v0
v_lshl_add_u32 v59, v54, 4, v59
v_lshlrev_b32 v59, 7, v59
s_mul_i32 s53, s44, 9
s_add_u32 s53, s53, s45
s_sub_u32 s53, s53, 9
s_add_u32 s55, s45, 5
s_lshl_b32 s55, s55, 13
v_add_u32 v61, s55, v59
v_add_u32 v62, 188416, v61
v_add_u32 v63, 376832, v61
v_min_u32 v63, 663424, v63
s_sub_u32 s54, s45, 18
s_cselect_b32 s53, s53, s54
s_waitcnt lgkmcnt(0)
s_load_dword s49, s[18:19], 0
s_cselect_b32 s62, s4, s6
s_cselect_b32 s63, s5, s7
s_lshl_b32 s53, s53, 13
s_add_u32 s62, s62, s53
s_addc_u32 s63, s63, 0
global_load_dword v60, v59, s[62:63]
global_load_dword v60, v61, s[6:7]
s_waitcnt vmcnt(1)
global_load_dword v60, v62, s[6:7]
s_waitcnt vmcnt(1)
global_load_dword v60, v63, s[6:7]
s_cmp_ge_u32 s45, 18
s_cbranch_scc1 L_helper
s_branch L_p2
L_p1:
v_lshrrev_b32 v58, 5, v1
v_bfe_u32 v56, v0, 2, 2
v_lshl_add_u32 v56, v58, 2, v56
v_and_b32 v57, 3, v0
v_xor_b32 v57, v57, v58
v_bfe_u32 v58, v0, 4, 1
v_lshl_add_u32 v57, v57, 1, v58
s_lshl_b32 s68, s44, 2
s_add_u32 s68, s68, s48
s_mul_i32 s52, s68, 18432
v_mul_u32_u24 v56, 1152, v56
v_lshlrev_b32 v57, 4, v57
v_add3_u32 v176, v56, v57, s52
v_xor_b32 v177, 64, v176
v_add_u32 v177, 9216, v177
v_lshrrev_b32 v56, 3, v0
v_bfe_u32 v57, v0, 1, 2
v_bfe_u32 v58, v0, 4, 3
v_and_b32 v58, 5, v58
v_add_u32 v58, v58, v58
v_mul_u32_u24 v58, 3, v58
v_bfe_u32 v58, v58, 2, 2
v_xor_b32 v57, v57, v58
v_and_b32 v58, 1, v0
v_lshlrev_b32 v58, 4, v58
v_lshl_add_u32 v57, v57, 5, v58
v_mul_u32_u24 v56, 1152, v56
s_lshl_b32 s52, s45, 7
v_add3_u32 v178, v56, v57, s52
s_mul_i32 s66, s48, 18432
s_waitcnt lgkmcnt(0)
s_mov_b32 s20, s4
s_and_b32 s21, s5, 0xffff
s_mov_b32 s22, 589824
s_mov_b32 s23, 0x20000
s_add_u32 m0, s66, 73728
s_nop 0
buffer_load_dwordx4 v176, s[20:23], 0 offen offset:0 lds
s_mov_b32 s24, s6
s_and_b32 s25, s7, 0xffff
s_mov_b32 s26, 663552
s_mov_b32 s27, 0x20000
s_add_u32 m0, s66, 82944
s_nop 0
buffer_load_dwordx4 v177, s[20:23], 0 offen offset:0 lds
s_load_dword s49, s[18:19], 0
s_mov_b32 s36, s18
s_and_b32 s37, s19, 0xffff
s_add_u32 m0, s66, 74624
s_nop 0
buffer_load_dwordx4 v176, s[20:23], 0 offen offset:128 lds
s_mov_b32 s38, 16777216
s_mov_b32 s39, 0x20000
s_mov_b32 s28, s10
s_and_b32 s29, s11, 0xffff
s_add_u32 m0, s66, 83840
s_nop 0
buffer_load_dwordx4 v177, s[20:23], 0 offen offset:128 lds
s_mov_b32 s30, 5308416
s_mov_b32 s31, 0x20000
s_mov_b32 s32, s12
s_add_u32 m0, s66, 75520
s_nop 0
buffer_load_dwordx4 v176, s[20:23], 0 offen offset:256 lds
s_and_b32 s33, s13, 0xffff
s_mov_b32 s34, 5308416
s_mov_b32 s35, 0x20000
s_mov_b32 s40, s14
s_add_u32 m0, s66, 84736
s_nop 0
buffer_load_dwordx4 v177, s[20:23], 0 offen offset:256 lds
s_and_b32 s41, s15, 0xffff
s_mov_b32 s42, 589824
s_mov_b32 s43, 0x20000
s_add_u32 m0, s70, 0
s_mov_b32 s83, 0
buffer_load_dwordx4 v178, s[24:27], s83 offen lds
s_add_u32 m0, s70, 4096
s_mov_b32 s83, 36864
buffer_load_dwordx4 v178, s[24:27], s83 offen lds
s_getreg_b32 s50, hwreg(HW_REG_XCC_ID)
s_add_u32 m0, s66, 76416
s_nop 0
buffer_load_dwordx4 v176, s[20:23], 0 offen offset:384 lds
v_and_b32 v2, 15, v0
v_bfe_u32 v3, v0, 4, 2
v_lshlrev_b32 v4, 4, v1
s_mov_b32 s64, 0xc0135761
s_mov_b32 s65, 0xbdd2d3e8
v_mov_b32 v16, 0x3f803f80
v_mov_b32 v17, 0x3f803f80
v_mov_b32 v18, 0x3f803f80
v_mov_b32 v19, 0x3f803f80
s_lshl_b32 s69, s45, 2
s_add_u32 s69, s69, s48
s_mul_i32 s52, s69, 57
s_lshr_b32 s52, s52, 9
s_lshl_b32 s52, s52, 2
s_lshr_b32 s52, 0x4031, s52
s_and_b32 s52, s52, 15
s_sub_u32 s52, s52, 2
v_mov_b32 v62, 148480
v_and_b32 v56, 1, v3
v_lshlrev_b32 v56, 8, v56
v_lshrrev_b32 v57, 1, v3
v_lshl_add_u32 v61, v57, 4, v56
v_add_u32 v58, s52, v2
v_and_b32 v56, 31, v58
v_lshrrev_b32 v63, 3, v56
v_mul_u32_u24 v63, 9216, v63
v_bfe_u32 v59, v56, 2, 1
v_lshl_add_u32 v63, v59, 9, v63
v_and_b32 v59, 3, v56
s_add_u32 m0, s66, 85632
s_nop 0
buffer_load_dwordx4 v177, s[20:23], 0 offen offset:384 lds
v_lshl_add_u32 v63, v59, 6, v63
v_bfe_u32 v59, v56, 2, 2
v_lshl_add_u32 v63, v59, 4, v63
v_xor_b32 v63, v63, v61
v_add_u32 v116, 73728, v63
v_xor_b32 v117, 32, v116
v_cmp_gt_u32 vcc, 32, v58
v_add_u32 v120, 36864, v116
v_add_u32 v121, 36864, v117
v_lshlrev_b32 v56, 4, v56
v_add_u32 v56, 147456, v56
v_add_u32 v57, 512, v56
v_cndmask_b32 v124, v62, v56, vcc
v_cndmask_b32 v126, v62, v57, vcc
v_add_u32 v58, s52, v2
v_add_u32 v58, 16, v58
v_and_b32 v56, 31, v58
v_lshrrev_b32 v63, 3, v56
v_mul_u32_u24 v63, 9216, v63
v_bfe_u32 v59, v56, 2, 1
v_lshl_add_u32 v63, v59, 9, v63
v_and_b32 v59, 3, v56
v_lshl_add_u32 v63, v59, 6, v63
v_bfe_u32 v59, v56, 2, 2
v_lshl_add_u32 v63, v59, 4, v63
v_xor_b32 v63, v63, v61
v_add_u32 v118, 73728, v63
v_xor_b32 v119, 32, v118
v_cmp_gt_u32 vcc, 32, v58
s_add_u32 m0, s70, 8192
s_mov_b32 s83, 73728
buffer_load_dwordx4 v178, s[24:27], s83 offen lds
v_add_u32 v122, 36864, v118
v_add_u32 v123, 36864, v119
v_lshlrev_b32 v56, 4, v56
v_add_u32 v56, 147456, v56
v_add_u32 v57, 512, v56
v_cndmask_b32 v125, v62, v56, vcc
v_cndmask_b32 v127, v62, v57, vcc
s_lshl_b32 s54, s48, 4
v_add_u32 v56, s54, v2
v_lshrrev_b32 v63, 3, v56
v_mul_u32_u24 v63, 9216, v63
v_bfe_u32 v59, v56, 2, 1
v_lshl_add_u32 v63, v59, 9, v63
v_and_b32 v59, 3, v56
v_lshl_add_u32 v63, v59, 6, v63
v_bfe_u32 v59, v56, 2, 2
v_lshl_add_u32 v63, v59, 4, v63
v_xor_b32 v63, v63, v61
v_add_u32 v179, 73728, v63
v_xor_b32 v180, 32, v179
v_lshlrev_b32 v185, 4, v56
v_add_u32 v185, 147456, v185
v_bfe_u32 v56, v1, 2, 2
v_lshl_add_u32 v56, v3, 3, v56
v_bfe_u32 v57, v1, 3, 2
v_xor_b32 v57, s48, v57
v_and_b32 v58, 3, v1
v_lshlrev_b32 v58, 3, v58
v_lshl_add_u32 v57, v57, 5, v58
s_add_u32 m0, s70, 12288
s_mov_b32 s83, 110592
buffer_load_dwordx4 v178, s[24:27], s83 offen lds
v_lshl_add_u32 v181, v56, 7, v57
v_add_u32 v182, 36864, v181
s_mul_i32 s54, s44, 72
s_lshr_b32 s52, s69, 1
s_add_u32 s54, s54, s52
s_lshl_b32 s54, s54, 10
s_and_b32 s53, s48, 1
s_lshl_b32 s53, s53, 3
s_add_u32 s54, s54, s53
s_add_u32 s54, s54, 1048576
v_add_u32 v183, s54, v4
s_lshl_b32 s52, s44, 8
s_lshl_b32 s53, s69, 2
s_add_u32 s52, s52, s53
s_add_u32 s52, s52, 65536
v_mov_b32 v184, s52
s_lshl_b32 s52, s44, 7
s_add_u32 s52, s52, 13312
v_min_u32 v186, 8, v1
v_lshlrev_b32 v186, 10, v186
v_add_u32 v186, s52, v186
s_mov_b32 s55, 18432
s_mov_b32 s56, 36864
s_mov_b32 s57, 55296
v_mov_b32 v68, 0
v_mov_b32 v69, 0
v_mov_b32 v70, 0
v_mov_b32 v71, 0x7f800000
s_waitcnt lgkmcnt(0)
s_add_u32 s49, s49, 1
v_mov_b32 v14, s49
ds_write_b128 v62, v[68:71]
s_waitcnt vmcnt(4)
s_barrier
ds_read_b128 a[4:7], v116 offset:0
ds_read_b128 a[8:11], v118 offset:0
s_add_u32 m0, s66, 77312
s_nop 0
buffer_load_dwordx4 v176, s[20:23], 0 offen offset:512 lds
ds_read_b128 a[12:15], v120 offset:0
ds_read_b128 a[16:19], v122 offset:0
s_add_u32 m0, s66, 86528
s_nop 0
buffer_load_dwordx4 v177, s[20:23], 0 offen offset:512 lds
ds_read_b64_tr_b16 a[0:1], v181 offset:0
ds_read_b64_tr_b16 a[2:3], v181 offset:512
ds_read_b128 v[80:83], v179 offset:0
ds_read_b128 v[84:87], v180 offset:0
ds_read_b128 v[88:91], v179 offset:1024
ds_read_b128 v[92:95], v180 offset:1024
ds_read_b128 v[96:99], v179 offset:2048
ds_read_b128 a[24:27], v117 offset:0
ds_read_b128 a[28:31], v119 offset:0
s_add_u32 m0, s70, 16384
s_mov_b32 s83, 147456
buffer_load_dwordx4 v178, s[24:27], s83 offen lds
ds_read_b128 a[32:35], v121 offset:0
ds_read_b128 a[36:39], v123 offset:0
s_add_u32 m0, s70, 20480
s_mov_b32 s83, 184320
buffer_load_dwordx4 v178, s[24:27], s83 offen lds
ds_read_b64_tr_b16 a[20:21], v181 offset:4096
ds_read_b64_tr_b16 a[22:23], v181 offset:4608
ds_read_b128 v[100:103], v180 offset:2048
s_waitcnt lgkmcnt(12)
v_mfma_f32_16x16x32_bf16 v[156:159], a[0:3], a[4:7], 0
s_waitcnt vmcnt(4)
s_barrier
ds_read_b128 a[44:47], v116 offset:1024
v_mfma_f32_16x16x32_bf16 v[160:163], a[0:3], a[8:11], 0
ds_read_b128 a[48:51], v118 offset:1024
v_mfma_f32_16x16x32_bf16 v[164:167], a[0:3], a[12:15], 0
s_add_u32 m0, s66, 78208
s_nop 0
buffer_load_dwordx4 v176, s[20:23], 0 offen offset:640 lds
ds_read_b128 a[52:55], v120 offset:1024
v_mfma_f32_16x16x32_bf16 v[168:171], a[0:3], a[16:19], 0
ds_read_b128 a[56:59], v122 offset:1024
v_mfma_f32_16x16x32_bf16 v[172:175], a[0:3], v[16:19], 0
ds_read_b64_tr_b16 a[40:41], v181 offset:8192
ds_read_b64_tr_b16 a[42:43], v181 offset:8704
s_waitcnt lgkmcnt(15)
v_mfma_f32_16x16x32_bf16 v[60:63], v[16:19], v[80:83], 0
ds_read_b128 v[104:107], v179 offset:3072
v_mfma_f32_16x16x32_bf16 v[64:67], v[80:83], v[80:83], 0
s_add_u32 m0, s66, 87424
s_nop 0
buffer_load_dwordx4 v177, s[20:23], 0 offen offset:640 lds
v_mfma_f32_16x16x32_bf16 v[60:63], v[16:19], v[84:87], v[60:63]
v_mfma_f32_16x16x32_bf16 v[64:67], v[84:87], v[84:87], v[64:67]
s_waitcnt lgkmcnt(8)
v_mfma_f32_16x16x32_bf16 v[156:159], a[20:23], a[24:27], v[156:159]
ds_read_b128 a[64:67], v117 offset:1024
v_mfma_f32_16x16x32_bf16 v[160:163], a[20:23], a[28:31], v[160:163]
ds_read_b128 a[68:71], v119 offset:1024
v_mfma_f32_16x16x32_bf16 v[164:167], a[20:23], a[32:35], v[164:167]
s_add_u32 m0, s70, 24576
s_mov_b32 s83, 221184
buffer_load_dwordx4 v178, s[24:27], s83 offen lds
ds_read_b128 a[72:75], v121 offset:1024
v_mfma_f32_16x16x32_bf16 v[168:171], a[20:23], a[36:39], v[168:171]
ds_read_b128 a[76:79], v123 offset:1024
v_mfma_f32_16x16x32_bf16 v[172:175], a[20:23], v[16:19], v[172:175]
ds_read_b64_tr_b16 a[60:61], v181 offset:12288
ds_read_b64_tr_b16 a[62:63], v181 offset:12800
v_mfma_f32_16x16x32_bf16 v[60:63], v[16:19], v[88:91], v[60:63]
ds_read_b128 v[108:111], v180 offset:3072
v_mfma_f32_16x16x32_bf16 v[64:67], v[88:91], v[88:91], v[64:67]
s_add_u32 m0, s70, 28672
s_mov_b32 s83, 258048
buffer_load_dwordx4 v178, s[24:27], s83 offen lds
v_mfma_f32_16x16x32_bf16 v[60:63], v[16:19], v[92:95], v[60:63]
v_mfma_f32_16x16x32_bf16 v[64:67], v[92:95], v[92:95], v[64:67]
s_waitcnt lgkmcnt(8)
v_mfma_f32_16x16x32_bf16 v[156:159], a[40:43], a[44:47], v[156:159]
s_waitcnt vmcnt(4)
s_barrier
ds_read_b128 a[84:87], v116 offset:2048
v_mfma_f32_16x16x32_bf16 v[160:163], a[40:43], a[48:51], v[160:163]
ds_read_b128 a[88:91], v118 offset:2048
v_mfma_f32_16x16x32_bf16 v[164:167], a[40:43], a[52:55], v[164:167]
s_add_u32 m0, s66, 79104
s_nop 0
buffer_load_dwordx4 v176, s[20:23], 0 offen offset:768 lds
ds_read_b128 a[92:95], v120 offset:2048
v_mfma_f32_16x16x32_bf16 v[168:171], a[40:43], a[56:59], v[168:171]
ds_read_b128 a[96:99], v122 offset:2048
v_mfma_f32_16x16x32_bf16 v[172:175], a[40:43], v[16:19], v[172:175]
ds_read_b64_tr_b16 a[80:81], v181 offset:16384
ds_read_b64_tr_b16 a[82:83], v181 offset:16896
v_mfma_f32_16x16x32_bf16 v[60:63], v[16:19], v[96:99], v[60:63]
ds_read_b128 v[80:83], v179 offset:4096
v_mfma_f32_16x16x32_bf16 v[64:67], v[96:99], v[96:99], v[64:67]
s_add_u32 m0, s66, 88320
s_nop 0
buffer_load_dwordx4 v177, s[20:23], 0 offen offset:768 lds
v_mfma_f32_16x16x32_bf16 v[60:63], v[16:19], v[100:103], v[60:63]
v_mfma_f32_16x16x32_bf16 v[64:67], v[100:103], v[100:103], v[64:67]
s_waitcnt lgkmcnt(8)
v_mfma_f32_16x16x32_bf16 v[156:159], a[60:63], a[64:67], v[156:159]
ds_read_b128 a[104:107], v117 offset:2048
v_mfma_f32_16x16x32_bf16 v[160:163], a[60:63], a[68:71], v[160:163]
ds_read_b128 a[108:111], v119 offset:2048
v_mfma_f32_16x16x32_bf16 v[164:167], a[60:63], a[72:75], v[164:167]
s_add_u32 m0, s70, 32768
s_mov_b32 s83, 294912
buffer_load_dwordx4 v178, s[24:27], s83 offen lds
ds_read_b128 a[112:115], v121 offset:2048
v_mfma_f32_16x16x32_bf16 v[168:171], a[60:63], a[76:79], v[168:171]
ds_read_b128 a[116:119], v123 offset:2048
v_mfma_f32_16x16x32_bf16 v[172:175], a[60:63], v[16:19], v[172:175]
ds_read_b64_tr_b16 a[100:101], v181 offset:20480
ds_read_b64_tr_b16 a[102:103], v181 offset:20992
v_mfma_f32_16x16x32_bf16 v[60:63], v[16:19], v[104:107], v[60:63]
ds_read_b128 v[84:87], v180 offset:4096
v_mfma_f32_16x16x32_bf16 v[64:67], v[104:107], v[104:107], v[64:67]
s_add_u32 m0, s70, 36864
s_mov_b32 s83, 331776
buffer_load_dwordx4 v178, s[24:27], s83 offen lds
s_waitcnt lgkmcnt(14)
v_mfma_f32_16x16x32_bf16 v[60:63], v[16:19], v[108:111], v[60:63]
v_mfma_f32_16x16x32_bf16 v[64:67], v[108:111], v[108:111], v[64:67]
s_waitcnt lgkmcnt(8)
v_mfma_f32_16x16x32_bf16 v[156:159], a[80:83], a[84:87], v[156:159]
s_waitcnt vmcnt(4)
s_barrier
ds_read_b128 a[4:7], v116 offset:3072
v_mfma_f32_16x16x32_bf16 v[160:163], a[80:83], a[88:91], v[160:163]
ds_read_b128 a[8:11], v118 offset:3072
v_mfma_f32_16x16x32_bf16 v[164:167], a[80:83], a[92:95], v[164:167]
s_add_u32 m0, s66, 80000
s_nop 0
buffer_load_dwordx4 v176, s[20:23], 0 offen offset:896 lds
ds_read_b128 a[12:15], v120 offset:3072
v_mfma_f32_16x16x32_bf16 v[168:171], a[80:83], a[96:99], v[168:171]
ds_read_b128 a[16:19], v122 offset:3072
v_mfma_f32_16x16x32_bf16 v[172:175], a[80:83], v[16:19], v[172:175]
ds_read_b64_tr_b16 a[0:1], v181 offset:24576
ds_read_b64_tr_b16 a[2:3], v181 offset:25088
s_waitcnt lgkmcnt(13)
v_mfma_f32_16x16x32_bf16 v[60:63], v[16:19], v[80:83], v[60:63]
ds_read_b128 v[88:91], v179 offset:5120
v_mfma_f32_16x16x32_bf16 v[64:67], v[80:83], v[80:83], v[64:67]
s_add_u32 m0, s66, 89216
s_nop 0
buffer_load_dwordx4 v177, s[20:23], 0 offen offset:896 lds
s_waitcnt lgkmcnt(7)
v_mfma_f32_16x16x32_bf16 v[60:63], v[16:19], v[84:87], v[60:63]
v_mfma_f32_16x16x32_bf16 v[64:67], v[84:87], v[84:87], v[64:67]
v_mfma_f32_16x16x32_bf16 v[156:159], a[100:103], a[104:107], v[156:159]
ds_read_b128 a[24:27], v117 offset:3072
v_mfma_f32_16x16x32_bf16 v[160:163], a[100:103], a[108:111], v[160:163]
s_add_u32 m0, s70, 40960
s_mov_b32 s83, 368640
buffer_load_dwordx4 v178, s[24:27], s83 offen lds
ds_read_b128 a[28:31], v119 offset:3072
v_mfma_f32_16x16x32_bf16 v[164:167], a[100:103], a[112:115], v[164:167]
ds_read_b128 a[32:35], v121 offset:3072
v_mfma_f32_16x16x32_bf16 v[168:171], a[100:103], a[116:119], v[168:171]
ds_read_b128 a[36:39], v123 offset:3072
v_mfma_f32_16x16x32_bf16 v[172:175], a[100:103], v[16:19], v[172:175]
s_add_u32 m0, s70, 45056
s_mov_b32 s83, 405504
buffer_load_dwordx4 v178, s[24:27], s83 offen lds
ds_read_b64_tr_b16 a[20:21], v181 offset:28672
ds_read_b64_tr_b16 a[22:23], v181 offset:29184
s_waitcnt lgkmcnt(6)
v_mfma_f32_16x16x32_bf16 v[60:63], v[16:19], v[88:91], v[60:63]
ds_read_b128 v[92:95], v180 offset:5120
v_mfma_f32_16x16x32_bf16 v[64:67], v[88:91], v[88:91], v[64:67]
v_mfma_f32_16x16x32_bf16 v[156:159], a[0:3], a[4:7], v[156:159]
s_waitcnt vmcnt(4)
s_barrier
ds_read_b128 a[44:47], v116 offset:4096
v_mfma_f32_16x16x32_bf16 v[160:163], a[0:3], a[8:11], v[160:163]
s_add_u32 m0, s66, 80896
s_nop 0
buffer_load_dwordx4 v176, s[20:23], 0 offen offset:1024 lds
ds_read_b128 a[48:51], v118 offset:4096
v_mfma_f32_16x16x32_bf16 v[164:167], a[0:3], a[12:15], v[164:167]
ds_read_b128 a[52:55], v120 offset:4096
v_mfma_f32_16x16x32_bf16 v[168:171], a[0:3], a[16:19], v[168:171]
ds_read_b128 a[56:59], v122 offset:4096
v_mfma_f32_16x16x32_bf16 v[172:175], a[0:3], v[16:19], v[172:175]
s_add_u32 m0, s66, 90112
s_nop 0
buffer_load_dwordx4 v177, s[20:23], 0 offen offset:1024 lds
ds_read_b64_tr_b16 a[40:41], v181 offset:32768
ds_read_b64_tr_b16 a[42:43], v181 offset:33280
s_waitcnt lgkmcnt(6)
v_mfma_f32_16x16x32_bf16 v[60:63], v[16:19], v[92:95], v[60:63]
ds_read_b128 v[96:99], v179 offset:6144
v_mfma_f32_16x16x32_bf16 v[64:67], v[92:95], v[92:95], v[64:67]
v_mfma_f32_16x16x32_bf16 v[156:159], a[20:23], a[24:27], v[156:159]
ds_read_b128 a[64:67], v117 offset:4096
v_mfma_f32_16x16x32_bf16 v[160:163], a[20:23], a[28:31], v[160:163]
s_add_u32 m0, s70, 49152
s_mov_b32 s83, 442368
buffer_load_dwordx4 v178, s[24:27], s83 offen lds
ds_read_b128 a[68:71], v119 offset:4096
v_mfma_f32_16x16x32_bf16 v[164:167], a[20:23], a[32:35], v[164:167]
ds_read_b128 a[72:75], v121 offset:4096
v_mfma_f32_16x16x32_bf16 v[168:171], a[20:23], a[36:39], v[168:171]
ds_read_b128 a[76:79], v123 offset:4096
v_mfma_f32_16x16x32_bf16 v[172:175], a[20:23], v[16:19], v[172:175]
s_add_u32 m0, s70, 53248
s_mov_b32 s83, 479232
buffer_load_dwordx4 v178, s[24:27], s83 offen lds
ds_read_b64_tr_b16 a[60:61], v182 offset:0
ds_read_b64_tr_b16 a[62:63], v182 offset:512
s_waitcnt lgkmcnt(6)
v_mfma_f32_16x16x32_bf16 v[60:63], v[16:19], v[96:99], v[60:63]
ds_read_b128 v[100:103], v180 offset:6144
v_mfma_f32_16x16x32_bf16 v[64:67], v[96:99], v[96:99], v[64:67]
v_mfma_f32_16x16x32_bf16 v[156:159], a[40:43], a[44:47], v[156:159]
s_waitcnt vmcnt(4)
s_barrier
ds_read_b128 a[84:87], v116 offset:5120
v_mfma_f32_16x16x32_bf16 v[160:163], a[40:43], a[48:51], v[160:163]
s_add_u32 m0, s70, 57344
s_mov_b32 s83, 516096
buffer_load_dwordx4 v178, s[24:27], s83 offen lds
ds_read_b128 a[88:91], v118 offset:5120
v_mfma_f32_16x16x32_bf16 v[164:167], a[40:43], a[52:55], v[164:167]
ds_read_b128 a[92:95], v120 offset:5120
v_mfma_f32_16x16x32_bf16 v[168:171], a[40:43], a[56:59], v[168:171]
ds_read_b128 a[96:99], v122 offset:5120
v_mfma_f32_16x16x32_bf16 v[172:175], a[40:43], v[16:19], v[172:175]
s_add_u32 m0, s70, 61440
s_mov_b32 s83, 552960
buffer_load_dwordx4 v178, s[24:27], s83 offen lds
ds_read_b64_tr_b16 a[80:81], v182 offset:4096
ds_read_b64_tr_b16 a[82:83], v182 offset:4608
s_waitcnt lgkmcnt(6)
v_mfma_f32_16x16x32_bf16 v[60:63], v[16:19], v[100:103], v[60:63]
ds_read_b128 v[104:107], v179 offset:7168
v_mfma_f32_16x16x32_bf16 v[64:67], v[100:103], v[100:103], v[64:67]
v_mfma_f32_16x16x32_bf16 v[156:159], a[60:63], a[64:67], v[156:159]
ds_read_b128 a[104:107], v117 offset:5120
v_mfma_f32_16x16x32_bf16 v[160:163], a[60:63], a[68:71], v[160:163]
s_add_u32 m0, s70, 65536
s_mov_b32 s83, 589824
buffer_load_dwordx4 v178, s[24:27], s83 offen lds
ds_read_b128 a[108:111], v119 offset:5120
v_mfma_f32_16x16x32_bf16 v[164:167], a[60:63], a[72:75], v[164:167]
ds_read_b128 a[112:115], v121 offset:5120
v_mfma_f32_16x16x32_bf16 v[168:171], a[60:63], a[76:79], v[168:171]
ds_read_b128 a[116:119], v123 offset:5120
v_mfma_f32_16x16x32_bf16 v[172:175], a[60:63], v[16:19], v[172:175]
s_add_u32 m0, s70, 69632
s_mov_b32 s83, 626688
buffer_load_dwordx4 v178, s[24:27], s83 offen lds
ds_read_b64_tr_b16 a[100:101], v182 offset:8192
ds_read_b64_tr_b16 a[102:103], v182 offset:8704
s_waitcnt lgkmcnt(6)
v_mfma_f32_16x16x32_bf16 v[60:63], v[16:19], v[104:107], v[60:63]
ds_read_b128 v[108:111], v180 offset:7168
v_mfma_f32_16x16x32_bf16 v[64:67], v[104:107], v[104:107], v[64:67]
v_mfma_f32_16x16x32_bf16 v[156:159], a[80:83], a[84:87], v[156:159]
s_waitcnt vmcnt(4)
s_barrier
ds_read_b128 a[4:7], v116 offset:6144
v_mfma_f32_16x16x32_bf16 v[160:163], a[80:83], a[88:91], v[160:163]
ds_read_b128 a[8:11], v118 offset:6144
v_mfma_f32_16x16x32_bf16 v[164:167], a[80:83], a[92:95], v[164:167]
ds_read_b128 a[12:15], v120 offset:6144
v_mfma_f32_16x16x32_bf16 v[168:171], a[80:83], a[96:99], v[168:171]
buffer_load_dwordx2 v[76:77], v186, s[36:39], 0 offen sc1
ds_read_b128 a[16:19], v122 offset:6144
v_mfma_f32_16x16x32_bf16 v[172:175], a[80:83], v[16:19], v[172:175]
ds_read_b64_tr_b16 a[0:1], v182 offset:12288
ds_read_b64_tr_b16 a[2:3], v182 offset:12800
s_waitcnt lgkmcnt(6)
v_mfma_f32_16x16x32_bf16 v[60:63], v[16:19], v[108:111], v[60:63]
ds_read_b128 v[80:83], v179 offset:8192
v_mfma_f32_16x16x32_bf16 v[64:67], v[108:111], v[108:111], v[64:67]
v_mfma_f32_16x16x32_bf16 v[156:159], a[100:103], a[104:107], v[156:159]
ds_read_b128 a[24:27], v117 offset:6144
v_mfma_f32_16x16x32_bf16 v[160:163], a[100:103], a[108:111], v[160:163]
ds_read_b128 a[28:31], v119 offset:6144
v_mfma_f32_16x16x32_bf16 v[164:167], a[100:103], a[112:115], v[164:167]
ds_read_b128 a[32:35], v121 offset:6144
v_mfma_f32_16x16x32_bf16 v[168:171], a[100:103], a[116:119], v[168:171]
ds_read_b128 a[36:39], v123 offset:6144
v_mfma_f32_16x16x32_bf16 v[172:175], a[100:103], v[16:19], v[172:175]
ds_read_b64_tr_b16 a[20:21], v182 offset:16384
ds_read_b64_tr_b16 a[22:23], v182 offset:16896
s_waitcnt lgkmcnt(6)
v_mfma_f32_16x16x32_bf16 v[60:63], v[16:19], v[80:83], v[60:63]
ds_read_b128 v[84:87], v180 offset:8192
v_mfma_f32_16x16x32_bf16 v[64:67], v[80:83], v[80:83], v[64:67]
v_mfma_f32_16x16x32_bf16 v[156:159], a[0:3], a[4:7], v[156:159]
s_waitcnt vmcnt(3)
s_barrier
ds_read_b128 a[44:47], v116 offset:7168
v_mfma_f32_16x16x32_bf16 v[160:163], a[0:3], a[8:11], v[160:163]
ds_read_b128 a[48:51], v118 offset:7168
v_mfma_f32_16x16x32_bf16 v[164:167], a[0:3], a[12:15], v[164:167]
ds_read_b128 a[52:55], v120 offset:7168
v_mfma_f32_16x16x32_bf16 v[168:171], a[0:3], a[16:19], v[168:171]
ds_read_b128 a[56:59], v122 offset:7168
v_mfma_f32_16x16x32_bf16 v[172:175], a[0:3], v[16:19], v[172:175]
ds_read_b64_tr_b16 a[40:41], v182 offset:20480
ds_read_b64_tr_b16 a[42:43], v182 offset:20992
s_waitcnt lgkmcnt(6)
v_mfma_f32_16x16x32_bf16 v[60:63], v[16:19], v[84:87], v[60:63]
v_mfma_f32_16x16x32_bf16 v[64:67], v[84:87], v[84:87], v[64:67]
v_mfma_f32_16x16x32_bf16 v[156:159], a[20:23], a[24:27], v[156:159]
ds_read_b128 a[64:67], v117 offset:7168
s_nop 0
v_mfma_f32_16x16x32_bf16 v[160:163], a[20:23], a[28:31], v[160:163]
ds_read_b128 a[68:71], v119 offset:7168
s_nop 0
v_mfma_f32_16x16x32_bf16 v[164:167], a[20:23], a[32:35], v[164:167]
ds_read_b128 a[72:75], v121 offset:7168
s_mov_b32 vcc_lo, 0x22222222
s_mov_b32 vcc_hi, 0x22222222
v_cndmask_b32 v64, v64, v65, vcc
v_mfma_f32_16x16x32_bf16 v[168:171], a[20:23], a[36:39], v[168:171]
ds_read_b128 a[76:79], v123 offset:7168
s_mov_b32 vcc_lo, 0x44444444
s_mov_b32 vcc_hi, 0x44444444
v_cndmask_b32 v64, v64, v66, vcc
v_mfma_f32_16x16x32_bf16 v[172:175], a[20:23], v[16:19], v[172:175]
ds_read_b64_tr_b16 a[60:61], v182 offset:24576
ds_read_b64_tr_b16 a[62:63], v182 offset:25088
s_mov_b32 vcc_lo, 0x88888888
s_mov_b32 vcc_hi, 0x88888888
v_cndmask_b32 v64, v64, v67, vcc
s_waitcnt lgkmcnt(6)
v_mfma_f32_16x16x32_bf16 v[156:159], a[40:43], a[44:47], v[156:159]
v_mul_f32 v68, 0xbae38e39, v60
v_mul_f32 v64, 0x3ae38e39, v64
v_fma_f32 v64, -v68, v68, v64
v_max_f32 v64, 0, v64
v_add_f32 v64, 0x3727c5ac, v64
v_rsq_f32 v60, v64
v_sqrt_f32 v71, v64
v_mul_f32 v69, s64, v60
v_mul_f32 v64, v60, v60
v_mul_f32 v70, s65, v60
v_mul_f32 v70, v70, v64
s_mov_b32 exec_lo, 0x00f0000f
s_mov_b32 exec_hi, 0xf0000f00
ds_write_b128 v185, v[68:71]
s_mov_b64 exec, -1
s_waitcnt lgkmcnt(0)
s_waitcnt vmcnt(1)
s_barrier
ds_read_b128 a[84:87], v116 offset:8192
ds_read_b128 a[88:91], v118 offset:8192
v_mfma_f32_16x16x32_bf16 v[160:163], a[40:43], a[48:51], v[160:163]
ds_read_b128 a[92:95], v120 offset:8192
v_mfma_f32_16x16x32_bf16 v[164:167], a[40:43], a[52:55], v[164:167]
ds_read_b128 a[96:99], v122 offset:8192
v_mfma_f32_16x16x32_bf16 v[168:171], a[40:43], a[56:59], v[168:171]
ds_read_b64_tr_b16 a[80:81], v182 offset:28672
ds_read_b64_tr_b16 a[82:83], v182 offset:29184
v_mfma_f32_16x16x32_bf16 v[172:175], a[40:43], v[16:19], v[172:175]
ds_read_b128 v[32:35], v124
ds_read_b128 v[36:39], v125
ds_read_b128 v[40:43], v126
ds_read_b128 v[44:47], v127
v_mfma_f32_16x16x32_bf16 v[156:159], a[60:63], a[64:67], v[156:159]
ds_read_b128 a[104:107], v117 offset:8192
v_mfma_f32_16x16x32_bf16 v[160:163], a[60:63], a[68:71], v[160:163]
ds_read_b128 a[108:111], v119 offset:8192
v_mfma_f32_16x16x32_bf16 v[164:167], a[60:63], a[72:75], v[164:167]
ds_read_b128 a[112:115], v121 offset:8192
v_mfma_f32_16x16x32_bf16 v[168:171], a[60:63], a[76:79], v[168:171]
ds_read_b128 a[116:119], v123 offset:8192
v_mfma_f32_16x16x32_bf16 v[172:175], a[60:63], v[16:19], v[172:175]
ds_read_b64_tr_b16 a[100:101], v182 offset:32768
ds_read_b64_tr_b16 a[102:103], v182 offset:33280
s_waitcnt lgkmcnt(10)
v_mfma_f32_16x16x32_bf16 v[156:159], a[80:83], a[84:87], v[156:159]
v_mfma_f32_16x16x32_bf16 v[160:163], a[80:83], a[88:91], v[160:163]
v_mfma_f32_16x16x32_bf16 v[164:167], a[80:83], a[92:95], v[164:167]
v_mfma_f32_16x16x32_bf16 v[168:171], a[80:83], a[96:99], v[168:171]
v_mfma_f32_16x16x32_bf16 v[172:175], a[80:83], v[16:19], v[172:175]
s_waitcnt lgkmcnt(0)
v_mfma_f32_16x16x32_bf16 v[156:159], a[100:103], a[104:107], v[156:159]
v_mfma_f32_16x16x32_bf16 v[160:163], a[100:103], a[108:111], v[160:163]
v_mfma_f32_16x16x32_bf16 v[164:167], a[100:103], a[112:115], v[164:167]
v_mfma_f32_16x16x32_bf16 v[168:171], a[100:103], a[116:119], v[168:171]
v_mfma_f32_16x16x32_bf16 v[172:175], a[100:103], v[16:19], v[172:175]
s_waitcnt vmcnt(0)
v_cmp_eq_u32 vcc, s49, v76
v_cmp_eq_u32 s[62:63], s50, v77
s_nop 3
s_and_b64 vcc, vcc, s[62:63]
s_cmp_eq_u64 vcc, -1
s_cselect_b32 s59, 1, 0
v_pk_fma_f32 v[52:53], v[32:33], v[172:173], v[156:157] op_sel_hi:[0,1,1]
v_pk_fma_f32 v[54:55], v[32:33], v[174:175], v[158:159] op_sel_hi:[0,1,1]
v_pk_fma_f32 v[56:57], v[36:37], v[172:173], v[160:161] op_sel_hi:[0,1,1]
v_pk_fma_f32 v[58:59], v[36:37], v[174:175], v[162:163] op_sel_hi:[0,1,1]
v_pk_mul_f32 v[60:61], v[52:53], v[52:53]
v_pk_mul_f32 v[62:63], v[54:55], v[54:55]
v_pk_mul_f32 v[64:65], v[56:57], v[56:57]
v_pk_mul_f32 v[66:67], v[58:59], v[58:59]
v_pk_fma_f32 v[60:61], v[60:61], v[34:35], v[32:33] op_sel:[0,0,1] op_sel_hi:[1,0,1]
v_pk_fma_f32 v[62:63], v[62:63], v[34:35], v[32:33] op_sel:[0,0,1] op_sel_hi:[1,0,1]
v_pk_fma_f32 v[64:65], v[64:65], v[38:39], v[36:37] op_sel:[0,0,1] op_sel_hi:[1,0,1]
v_pk_fma_f32 v[66:67], v[66:67], v[38:39], v[36:37] op_sel:[0,0,1] op_sel_hi:[1,0,1]
v_pk_mul_f32 v[60:61], v[60:61], v[52:53]
v_pk_mul_f32 v[62:63], v[62:63], v[54:55]
v_pk_mul_f32 v[64:65], v[64:65], v[56:57]
v_pk_mul_f32 v[66:67], v[66:67], v[58:59]
v_exp_f32 v60, v60
v_exp_f32 v61, v61
v_exp_f32 v62, v62
v_exp_f32 v63, v63
v_exp_f32 v64, v64
v_exp_f32 v65, v65
v_exp_f32 v66, v66
v_exp_f32 v67, v67
v_pk_fma_f32 v[60:61], v[60:61], v[34:35], v[34:35] op_sel:[0,1,1] op_sel_hi:[1,1,1]
v_pk_fma_f32 v[62:63], v[62:63], v[34:35], v[34:35] op_sel:[0,1,1] op_sel_hi:[1,1,1]
v_pk_fma_f32 v[64:65], v[64:65], v[38:39], v[38:39] op_sel:[0,1,1] op_sel_hi:[1,1,1]
v_pk_fma_f32 v[66:67], v[66:67], v[38:39], v[38:39] op_sel:[0,1,1] op_sel_hi:[1,1,1]
v_rcp_f32 v60, v60
v_rcp_f32 v61, v61
v_rcp_f32 v62, v62
v_rcp_f32 v63, v63
v_rcp_f32 v64, v64
v_rcp_f32 v65, v65
v_rcp_f32 v66, v66
v_rcp_f32 v67, v67
v_pk_mul_f32 v[52:53], v[52:53], v[60:61]
v_pk_mul_f32 v[54:55], v[54:55], v[62:63]
v_pk_mul_f32 v[56:57], v[56:57], v[64:65]
v_pk_mul_f32 v[58:59], v[58:59], v[66:67]
v_cvt_pk_bf16_f32 v68, v52, v53
v_cvt_pk_bf16_f32 v69, v54, v55
v_cvt_pk_bf16_f32 v70, v56, v57
v_cvt_pk_bf16_f32 v71, v58, v59
s_cmp_eq_u32 s59, 0
s_cbranch_scc1 L_rem_1
buffer_store_dwordx2 v[68:69], v183, s[36:39], 0 offen
buffer_store_dwordx2 v[70:71], v183, s[36:39], s55 offen
L_bak_2:
v_pk_fma_f32 v[52:53], v[40:41], v[172:173], v[164:165] op_sel_hi:[0,1,1]
v_pk_fma_f32 v[54:55], v[40:41], v[174:175], v[166:167] op_sel_hi:[0,1,1]
v_pk_fma_f32 v[56:57], v[44:45], v[172:173], v[168:169] op_sel_hi:[0,1,1]
v_pk_fma_f32 v[58:59], v[44:45], v[174:175], v[170:171] op_sel_hi:[0,1,1]
v_pk_mul_f32 v[60:61], v[52:53], v[52:53]
v_pk_mul_f32 v[62:63], v[54:55], v[54:55]
v_pk_mul_f32 v[64:65], v[56:57], v[56:57]
v_pk_mul_f32 v[66:67], v[58:59], v[58:59]
v_pk_fma_f32 v[60:61], v[60:61], v[42:43], v[40:41] op_sel:[0,0,1] op_sel_hi:[1,0,1]
v_pk_fma_f32 v[62:63], v[62:63], v[42:43], v[40:41] op_sel:[0,0,1] op_sel_hi:[1,0,1]
v_pk_fma_f32 v[64:65], v[64:65], v[46:47], v[44:45] op_sel:[0,0,1] op_sel_hi:[1,0,1]
v_pk_fma_f32 v[66:67], v[66:67], v[46:47], v[44:45] op_sel:[0,0,1] op_sel_hi:[1,0,1]
v_pk_mul_f32 v[60:61], v[60:61], v[52:53]
v_pk_mul_f32 v[62:63], v[62:63], v[54:55]
v_pk_mul_f32 v[64:65], v[64:65], v[56:57]
v_pk_mul_f32 v[66:67], v[66:67], v[58:59]
v_exp_f32 v60, v60
v_exp_f32 v61, v61
v_exp_f32 v62, v62
v_exp_f32 v63, v63
v_exp_f32 v64, v64
v_exp_f32 v65, v65
v_exp_f32 v66, v66
v_exp_f32 v67, v67
v_pk_fma_f32 v[60:61], v[60:61], v[42:43], v[42:43] op_sel:[0,1,1] op_sel_hi:[1,1,1]
v_pk_fma_f32 v[62:63], v[62:63], v[42:43], v[42:43] op_sel:[0,1,1] op_sel_hi:[1,1,1]
v_pk_fma_f32 v[64:65], v[64:65], v[46:47], v[46:47] op_sel:[0,1,1] op_sel_hi:[1,1,1]
v_pk_fma_f32 v[66:67], v[66:67], v[46:47], v[46:47] op_sel:[0,1,1] op_sel_hi:[1,1,1]
v_rcp_f32 v60, v60
v_rcp_f32 v61, v61
v_rcp_f32 v62, v62
v_rcp_f32 v63, v63
v_rcp_f32 v64, v64
v_rcp_f32 v65, v65
v_rcp_f32 v66, v66
v_rcp_f32 v67, v67
v_pk_mul_f32 v[52:53], v[52:53], v[60:61]
v_pk_mul_f32 v[54:55], v[54:55], v[62:63]
v_pk_mul_f32 v[56:57], v[56:57], v[64:65]
v_pk_mul_f32 v[58:59], v[58:59], v[66:67]
v_cvt_pk_bf16_f32 v72, v52, v53
v_cvt_pk_bf16_f32 v73, v54, v55
v_cvt_pk_bf16_f32 v74, v56, v57
v_cvt_pk_bf16_f32 v75, v58, v59
s_cmp_eq_u32 s59, 0
s_cbranch_scc1 L_rem_3
buffer_store_dwordx2 v[72:73], v183, s[36:39], s56 offen
buffer_store_dwordx2 v[74:75], v183, s[36:39], s57 offen
L_bak_4:
s_lshr_b32 s46, s45, 2
s_and_b32 s47, s45, 3
v_lshlrev_b32 v13, 3, v1
s_lshl_b32 s60, s48, 11
s_lshl_b32 s52, s48, 3
v_add_u32 v56, s52, v3
v_lshrrev_b32 v57, 1, v2
v_xor_b32 v57, v57, v3
v_and_b32 v58, 1, v2
v_lshlrev_b32 v58, 4, v58
v_lshl_add_u32 v57, v57, 5, v58
v_xor_b32 v58, 128, v57
s_mul_i32 s53, s44, 1152
s_lshl_b32 s54, s47, 8
s_add_u32 s53, s53, s54
v_mul_u32_u24 v5, 9216, v56
v_add_u32 v5, s53, v5
v_add_u32 v6, 35840, v5
v_add_u32 v5, v5, v57
v_add_u32 v6, v6, v58
s_mul_i32 s53, s44, 663552
s_add_u32 s53, s53, s54
v_mul_u32_u24 v7, 1152, v56
v_add_u32 v7, s53, v7
v_add_u32 v8, 3584, v7
v_add_u32 v7, v7, v57
v_add_u32 v8, v8, v58
v_lshrrev_b32 v56, 3, v1
v_and_b32 v57, 7, v1
v_lshlrev_b32 v57, 7, v57
v_mul_u32_u24 v225, 9216, v56
v_add_u32 v225, v225, v57
v_mul_u32_u24 v254, 1152, v56
v_add_u32 v254, v254, v57
s_sub_u32 s51, s45, 0
s_lshl_b32 s51, s51, 2
s_add_u32 s51, s51, s48
s_waitcnt vmcnt(0)
s_cmp_eq_u32 s59, 0
s_cbranch_scc1 L_rem_5
buffer_store_dword v14, v184, s[36:39], 0 offen
L_bak_6:
s_lshl_b32 s52, s2, 7
s_add_u32 s52, s52, 4096
v_mov_b32 v52, s52
v_mov_b32 v54, s49
v_mov_b32 v55, s50
s_cmp_lg_u32 s48, 0
s_cbranch_scc1 L_7
buffer_store_dwordx2 v[54:55], v52, s[36:39], 0 offen sc1
L_7:
s_barrier
s_sub_u32 s54, s51, 0
s_mul_i32 s52, s54, 9216
s_mul_i32 s53, s44, 663552
s_add_u32 s52, s52, s53
s_add_u32 s52, s52, 0
s_cmp_ge_u32 s54, 36
s_cbranch_scc1 L_8
buffer_load_dword v60, v254, s[32:35], s52 offen
L_8:
v_lshrrev_b32 v56, 2, v1
v_and_b32 v57, 3, v1
v_lshlrev_b32 v57, 3, v57
v_lshl_add_u32 v11, v56, 5, v57
v_add_u32 v15, 98304, v11
v_and_b32 v58, 7, v56
s_lshl_b32 s52, s48, 1
v_xor_b32 v58, s52, v58
v_lshl_add_u32 v58, v58, 5, v57
v_lshl_add_u32 v58, v56, 8, v58
v_add_u32 v9, 98304, v58
v_xor_b32 v58, 32, v58
v_add_u32 v10, 98304, v58
v_subrev_u32 v242, 16384, v9
v_subrev_u32 v243, 16384, v10
v_add_u32 v224, 4608, v4
v_add_u32 v12, 41472, v4
v_mov_b32 v16, 0x3f803f80
v_mov_b32 v17, 0x3f803f80
v_mov_b32 v18, 0x3f803f80
v_mov_b32 v19, 0x3f803f80
s_lshl_b32 s75, s48, 12
s_mul_i32 s52, s48, 18432
v_add_u32 v232, s52, v224
s_add_u32 s71, s52, 16384
s_mul_i32 s78, s46, 81920
s_add_u32 s78, s78, 2097152
s_lshl_b32 s55, s44, 3
s_add_u32 s56, s55, s47
s_mul_i32 s81, s56, 18432
s_add_u32 s81, s81, 3145728
s_lshl_b32 s72, s48, 9
s_add_u32 s72, s72, 16384
s_add_u32 s55, s55, s46
s_mul_i32 s79, s55, 73728
s_add_u32 s79, s79, 5242880
s_lshr_b32 s53, s47, 1
s_lshl_b32 s53, s53, 10
s_add_u32 s53, s53, s71
s_add_u32 s53, s53, s79
s_and_b32 s54, s47, 1
s_lshl_b32 s54, s54, 3
s_add_u32 s54, s54, s53
v_add_u32 v229, s54, v4
s_lshl_b32 s52, s47, 2
s_add_u32 s52, s52, s48
s_lshl_b32 s54, s52, 10
s_add_u32 s54, s54, s79
v_add_u32 v228, s54, v4
s_lshl_b32 s55, s55, 10
s_add_u32 s55, s55, 196608
v_lshlrev_b32 v56, 2, v2
v_add_u32 v231, s55, v56
s_lshl_b32 s52, s52, 2
s_add_u32 s52, s52, s55
v_mov_b32 v230, s52
v_and_b32 v56, 3, v1
s_lshl_b32 s52, s44, 9
s_add_u32 s52, s52, 163840
v_lshlrev_b32 v57, 7, v56
v_add_u32 v239, s52, v57
s_lshl_b32 s52, s46, 5
s_add_u32 s52, s52, s44
s_lshl_b32 s52, s52, 7
s_add_u32 s52, s52, 4096
v_lshlrev_b32 v57, 10, v56
v_add_u32 v240, s52, v57
s_mul_i32 s52, s46, 1152
s_add_u32 s52, s52, 73728
v_min_u32 v57, 8, v1
v_lshlrev_b32 v57, 7, v57
v_add_u32 v238, s52, v57
s_and_b32 s53, s44, 1
s_lshl_b32 s53, s53, 1
s_add_u32 s53, s53, s48
s_lshl_b32 s54, s47, 2
s_add_u32 s53, s53, s54
s_lshr_b32 s54, s47, 1
s_add_u32 s54, s54, 16
s_cmp_ge_u32 s48, 2
s_cselect_b32 s53, s54, s53
s_lshl_b32 s53, s53, 10
s_lshr_b32 s52, s44, 1
s_mul_i32 s52, s52, 18432
s_add_u32 s52, s52, s53
v_add_u32 v233, s52, v224
s_mul_i32 s80, s45, 147456
s_add_u32 s80, s80, 10485760
s_mul_i32 s52, s44, 4608
s_add_u32 s52, s52, s80
s_add_u32 s53, s70, s52
v_add_u32 v234, s53, v4
s_mul_i32 s53, s48, 36864
s_add_u32 s53, s53, s52
s_add_u32 s53, s53, 4096
v_add_u32 v235, s53, v13
s_lshl_b32 s52, s45, 10
s_add_u32 s52, s52, 131072
v_and_b32 v56, 7, v1
v_lshlrev_b32 v56, 7, v56
v_lshl_add_u32 v56, v3, 2, v56
v_add_u32 v237, s52, v56
s_lshl_b32 s53, s44, 5
s_add_u32 s53, s53, s48
s_lshl_b32 s53, s53, 2
s_add_u32 s52, s52, s53
v_mov_b32 v236, s52
v_mul_u32_u24 v253, 1152, v2
v_lshl_add_u32 v253, v3, 3, v253
v_mov_b32 v52, -1
v_mov_b32 v53, -1
v_mov_b32 v54, -1
v_mov_b32 v55, -1
s_mov_b32 s52, 0
buffer_store_dwordx4 v[52:55], v234, s[36:39], s52 offen sc1
s_mov_b32 s52, 36864
buffer_store_dwordx4 v[52:55], v234, s[36:39], s52 offen sc1
s_mov_b32 s52, 73728
buffer_store_dwordx4 v[52:55], v234, s[36:39], s52 offen sc1
s_mov_b32 s52, 110592
buffer_store_dwordx4 v[52:55], v234, s[36:39], s52 offen sc1
buffer_store_dwordx2 v[52:53], v235, s[36:39], 0 offen sc1
s_nop 0
buffer_load_dword v248, v239, s[36:39], 0 offen sc1
buffer_load_dwordx2 v[250:251], v240, s[36:39], 0 offen sc1
s_add_u32 m0, s60, 114688
s_mov_b32 s58, 0
buffer_load_dwordx4 v5, s[28:31], s58 offen lds
s_add_u32 m0, s60, 114688
s_nop 0
buffer_load_dwordx4 v6, s[28:31], s58 offen offset:1024 lds
s_add_u32 m0, s60, 122880
s_mov_b32 s58, 294912
buffer_load_dwordx4 v5, s[28:31], s58 offen lds
s_add_u32 m0, s60, 122880
s_nop 0
buffer_load_dwordx4 v6, s[28:31], s58 offen offset:1024 lds
s_add_u32 m0, s60, 131072
s_mov_b32 s58, 589824
buffer_load_dwordx4 v5, s[28:31], s58 offen lds
s_add_u32 m0, s60, 131072
s_nop 0
buffer_load_dwordx4 v6, s[28:31], s58 offen offset:1024 lds
s_add_u32 m0, s60, 139264
s_mov_b32 s58, 884736
buffer_load_dwordx4 v5, s[28:31], s58 offen lds
s_add_u32 m0, s60, 139264
s_nop 0
buffer_load_dwordx4 v6, s[28:31], s58 offen offset:1024 lds
s_add_u32 m0, s60, 147456
s_mov_b32 s58, 1179648
buffer_load_dwordx4 v5, s[28:31], s58 offen lds
s_add_u32 m0, s60, 147456
s_nop 0
buffer_load_dwordx4 v6, s[28:31], s58 offen offset:1024 lds
s_add_u32 m0, s60, 155648
s_mov_b32 s58, 1474560
buffer_load_dwordx4 v5, s[28:31], s58 offen lds
s_add_u32 m0, s60, 155648
s_nop 0
buffer_load_dwordx4 v6, s[28:31], s58 offen offset:1024 lds
s_waitcnt vmcnt(8)
s_waitcnt lgkmcnt(0)
s_barrier
s_add_u32 m0, s60, 98304
s_mov_b32 s58, 1769472
buffer_load_dwordx4 v5, s[28:31], s58 offen lds
ds_read_b64_tr_b16 a[0:1], v9 offset:16384
v_cmp_eq_u32 vcc, s49, v250
v_cmp_eq_u32 s[62:63], s50, v251
s_nop 3
s_and_b64 vcc, vcc, s[62:63]
s_cmp_eq_u64 vcc, -1
s_cselect_b32 s59, 1, 0
v_cmp_ne_u32 vcc, s49, v248
s_cbranch_vccnz L_slow_9
L_bak_10:
ds_read_b64_tr_b16 a[2:3], v9 offset:20480
s_add_u32 m0, s60, 98304
s_nop 0
buffer_load_dwordx4 v6, s[28:31], s58 offen offset:1024 lds
ds_read_b64_tr_b16 a[4:5], v10 offset:16384
s_add_u32 m0, s75, 4608
s_add_u32 s52, s81, s75
buffer_load_dwordx4 v4, s[36:39], s52 offen offset:0 sc1 lds
buffer_load_dwordx4 v4, s[36:39], s52 offen offset:1024 sc1 lds
buffer_load_dwordx4 v4, s[36:39], s52 offen offset:2048 sc1 lds
buffer_load_dwordx4 v4, s[36:39], s52 offen offset:3072 sc1 lds
ds_read_b64_tr_b16 a[6:7], v10 offset:20480
s_add_u32 m0, s60, 106496
s_mov_b32 s58, 2064384
buffer_load_dwordx4 v5, s[28:31], s58 offen lds
ds_read_b64_tr_b16 a[8:9], v9 offset:24576
s_add_u32 m0, s72, 4608
s_add_u32 s52, s81, s72
buffer_load_dwordx4 v4, s[36:39], s52 offen sc1 lds
ds_read_b64_tr_b16 a[10:11], v9 offset:28672
s_add_u32 m0, s60, 106496
s_nop 0
buffer_load_dwordx4 v6, s[28:31], s58 offen offset:1024 lds
ds_read_b64_tr_b16 a[12:13], v10 offset:24576
s_mul_i32 s52, s46, 2304
s_add_u32 s52, s52, s81
s_add_u32 s52, s52, 73728
v_min_u32 v52, 2176, v241
s_cmp_lg_u32 s48, 0
s_cbranch_scc1 L_12
buffer_load_dword v252, v52, s[36:39], s52 offen sc1
L_12:
ds_read_b64_tr_b16 a[14:15], v10 offset:28672
s_waitcnt vmcnt(13)
s_waitcnt lgkmcnt(0)
s_barrier
s_add_u32 m0, s60, 114688
s_mov_b32 s58, 2359296
buffer_load_dwordx4 v5, s[28:31], s58 offen lds
ds_read_b64_tr_b16 a[16:17], v9 offset:32768
ds_read_b64_tr_b16 a[18:19], v9 offset:36864
ds_read_b64_tr_b16 a[20:21], v10 offset:32768
s_add_u32 m0, s60, 114688
s_nop 0
buffer_load_dwordx4 v6, s[28:31], s58 offen offset:1024 lds
ds_read_b64_tr_b16 a[22:23], v10 offset:36864
ds_read_b64_tr_b16 a[24:25], v9 offset:40960
ds_read_b64_tr_b16 a[26:27], v9 offset:45056
s_add_u32 m0, s60, 122880
s_mov_b32 s58, 2654208
buffer_load_dwordx4 v5, s[28:31], s58 offen lds
ds_read_b64_tr_b16 a[28:29], v10 offset:40960
ds_read_b64_tr_b16 a[30:31], v10 offset:45056
v_mfma_f32_16x16x32_bf16 v[20:23], a[0:3], v[16:19], 0
s_add_u32 m0, s60, 122880
s_nop 0
buffer_load_dwordx4 v6, s[28:31], s58 offen offset:1024 lds
v_mfma_f32_16x16x32_bf16 v[24:27], a[4:7], v[16:19], 0
v_mfma_f32_16x16x32_bf16 v[20:23], a[8:11], v[16:19], v[20:23]
v_mfma_f32_16x16x32_bf16 v[24:27], a[12:15], v[16:19], v[24:27]
s_waitcnt vmcnt(13)
s_waitcnt lgkmcnt(0)
s_barrier
s_add_u32 m0, s60, 131072
s_mov_b32 s58, 2949120
buffer_load_dwordx4 v5, s[28:31], s58 offen lds
ds_read_b64_tr_b16 a[32:33], v9 offset:49152
ds_read_b64_tr_b16 a[34:35], v9 offset:53248
ds_read_b64_tr_b16 a[36:37], v10 offset:49152
s_add_u32 m0, s60, 131072
s_nop 0
buffer_load_dwordx4 v6, s[28:31], s58 offen offset:1024 lds
ds_read_b64_tr_b16 a[38:39], v10 offset:53248
ds_read_b64_tr_b16 a[40:41], v9 offset:57344
ds_read_b64_tr_b16 a[42:43], v9 offset:61440
s_add_u32 m0, s60, 139264
s_mov_b32 s58, 3244032
buffer_load_dwordx4 v5, s[28:31], s58 offen lds
ds_read_b64_tr_b16 a[44:45], v10 offset:57344
ds_read_b64_tr_b16 a[46:47], v10 offset:61440
v_mfma_f32_16x16x32_bf16 v[20:23], a[16:19], v[16:19], v[20:23]
s_add_u32 m0, s60, 139264
s_nop 0
buffer_load_dwordx4 v6, s[28:31], s58 offen offset:1024 lds
v_mfma_f32_16x16x32_bf16 v[24:27], a[20:23], v[16:19], v[24:27]
v_mfma_f32_16x16x32_bf16 v[20:23], a[24:27], v[16:19], v[20:23]
v_mfma_f32_16x16x32_bf16 v[24:27], a[28:31], v[16:19], v[24:27]
s_waitcnt vmcnt(9)
s_waitcnt vmcnt(8)
s_waitcnt lgkmcnt(0)
s_barrier
s_add_u32 m0, s60, 147456
s_mov_b32 s58, 3538944
buffer_load_dwordx4 v5, s[28:31], s58 offen lds
ds_read_b64_tr_b16 a[48:49], v9 offset:0
ds_read_b64_tr_b16 a[144:145], v11 offset:4608
ds_read_b64_tr_b16 a[50:51], v9 offset:4096
ds_read_b64_tr_b16 a[146:147], v11 offset:5120
ds_read_b64_tr_b16 a[52:53], v10 offset:0
ds_read_b64_tr_b16 a[148:149], v11 offset:5632
s_add_u32 m0, s60, 147456
s_nop 0
buffer_load_dwordx4 v6, s[28:31], s58 offen offset:1024 lds
ds_read_b64_tr_b16 a[54:55], v10 offset:4096
ds_read_b64_tr_b16 a[150:151], v11 offset:6144
ds_read_b64_tr_b16 a[56:57], v9 offset:8192
ds_read_b64_tr_b16 a[152:153], v11 offset:6656
ds_read_b64_tr_b16 a[58:59], v9 offset:12288
ds_read_b64_tr_b16 a[154:155], v11 offset:7168
s_add_u32 m0, s60, 155648
s_mov_b32 s58, 3833856
buffer_load_dwordx4 v5, s[28:31], s58 offen lds
ds_read_b64_tr_b16 a[60:61], v10 offset:8192
ds_read_b64_tr_b16 a[156:157], v11 offset:7680
ds_read_b64_tr_b16 a[62:63], v10 offset:12288
ds_read_b64_tr_b16 a[158:159], v11 offset:8192
v_mfma_f32_16x16x32_bf16 v[20:23], a[32:35], v[16:19], v[20:23]
ds_read_b64_tr_b16 a[160:161], v11 offset:8704
s_add_u32 m0, s60, 155648
s_nop 0
buffer_load_dwordx4 v6, s[28:31], s58 offen offset:1024 lds
v_mfma_f32_16x16x32_bf16 v[24:27], a[36:39], v[16:19], v[24:27]
ds_read_b64_tr_b16 a[162:163], v11 offset:9216
v_mfma_f32_16x16x32_bf16 v[20:23], a[40:43], v[16:19], v[20:23]
ds_read_b64_tr_b16 a[164:165], v11 offset:9728
v_mfma_f32_16x16x32_bf16 v[24:27], a[44:47], v[16:19], v[24:27]
ds_read_b64_tr_b16 a[166:167], v11 offset:10240
s_waitcnt vmcnt(8)
s_waitcnt lgkmcnt(0)
s_barrier
s_add_u32 m0, s60, 98304
s_mov_b32 s58, 4128768
buffer_load_dwordx4 v5, s[28:31], s58 offen lds
ds_read_b64_tr_b16 a[64:65], v9 offset:16384
v_mfma_f32_16x16x32_bf16 v[28:31], a[144:147], v[16:19], 0
v_mfma_f32_16x16x32_bf16 v[28:31], a[148:151], v[16:19], v[28:31]
ds_read_b64_tr_b16 a[66:67], v9 offset:20480
v_mfma_f32_16x16x32_bf16 v[28:31], a[152:155], v[16:19], v[28:31]
ds_read_b64_tr_b16 a[68:69], v10 offset:16384
v_mfma_f32_16x16x32_bf16 v[28:31], a[156:159], v[16:19], v[28:31]
v_mfma_f32_16x16x32_bf16 v[28:31], a[160:163], v[16:19], v[28:31]
s_add_u32 m0, s60, 98304
s_nop 0
buffer_load_dwordx4 v6, s[28:31], s58 offen offset:1024 lds
ds_read_b64_tr_b16 a[70:71], v10 offset:20480
v_mfma_f32_16x16x32_bf16 v[28:31], a[164:167], v[16:19], v[28:31]
ds_read_b64_tr_b16 a[72:73], v9 offset:24576
ds_read_b64_tr_b16 a[168:169], v11 offset:10752
ds_read_b64_tr_b16 a[170:171], v11 offset:11264
ds_read_b64_tr_b16 a[74:75], v9 offset:28672
ds_read_b64_tr_b16 a[172:173], v11 offset:11776
s_add_u32 m0, s60, 106496
s_mov_b32 s58, 4423680
buffer_load_dwordx4 v5, s[28:31], s58 offen lds
ds_read_b64_tr_b16 a[76:77], v10 offset:24576
ds_read_b64_tr_b16 a[174:175], v11 offset:12288
ds_read_b64_tr_b16 a[176:177], v11 offset:12800
ds_read_b64_tr_b16 a[78:79], v10 offset:28672
ds_read_b64_tr_b16 a[178:179], v11 offset:13312
v_mfma_f32_16x16x32_bf16 v[20:23], a[48:51], v[16:19], v[20:23]
ds_read_b64_tr_b16 a[180:181], v11 offset:13824
ds_read_b64_tr_b16 a[182:183], v11 offset:14336
s_add_u32 m0, s60, 106496
s_nop 0
buffer_load_dwordx4 v6, s[28:31], s58 offen offset:1024 lds
v_mfma_f32_16x16x32_bf16 v[24:27], a[52:55], v[16:19], v[24:27]
ds_read_b64_tr_b16 a[184:185], v11 offset:14848
v_mfma_f32_16x16x32_bf16 v[20:23], a[56:59], v[16:19], v[20:23]
ds_read_b64_tr_b16 a[186:187], v11 offset:15360
ds_read_b64_tr_b16 a[188:189], v11 offset:15872
v_mfma_f32_16x16x32_bf16 v[24:27], a[60:63], v[16:19], v[24:27]
ds_read_b64_tr_b16 a[190:191], v11 offset:16384
s_waitcnt vmcnt(8)
s_waitcnt lgkmcnt(0)
s_barrier
s_add_u32 m0, s60, 114688
s_mov_b32 s58, 4718592
buffer_load_dwordx4 v5, s[28:31], s58 offen lds
ds_read_b64_tr_b16 a[80:81], v9 offset:32768
v_mfma_f32_16x16x32_bf16 v[28:31], a[168:171], v[16:19], v[28:31]
v_mfma_f32_16x16x32_bf16 v[28:31], a[172:175], v[16:19], v[28:31]
ds_read_b64_tr_b16 a[82:83], v9 offset:36864
v_mfma_f32_16x16x32_bf16 v[28:31], a[176:179], v[16:19], v[28:31]
ds_read_b64_tr_b16 a[84:85], v10 offset:32768
v_mfma_f32_16x16x32_bf16 v[28:31], a[180:183], v[16:19], v[28:31]
v_mfma_f32_16x16x32_bf16 v[28:31], a[184:187], v[16:19], v[28:31]
s_add_u32 m0, s60, 114688
s_nop 0
buffer_load_dwordx4 v6, s[28:31], s58 offen offset:1024 lds
ds_read_b64_tr_b16 a[86:87], v10 offset:36864
v_mfma_f32_16x16x32_bf16 v[28:31], a[188:191], v[16:19], v[28:31]
ds_read_b64_tr_b16 a[88:89], v9 offset:40960
ds_read_b64_tr_b16 a[192:193], v11 offset:16896
ds_read_b64_tr_b16 a[194:195], v11 offset:17408
ds_read_b64_tr_b16 a[90:91], v9 offset:45056
ds_read_b64_tr_b16 a[196:197], v11 offset:17920
s_add_u32 m0, s60, 122880
s_mov_b32 s58, 5013504
buffer_load_dwordx4 v5, s[28:31], s58 offen lds
ds_read_b64_tr_b16 a[92:93], v10 offset:40960
ds_read_b64_tr_b16 a[198:199], v11 offset:18432
ds_read_b64_tr_b16 a[200:201], v11 offset:18944
ds_read_b64_tr_b16 a[94:95], v10 offset:45056
ds_read_b64_tr_b16 a[202:203], v11 offset:19456
v_mfma_f32_16x16x32_bf16 v[20:23], a[64:67], v[16:19], v[20:23]
ds_read_b64_tr_b16 a[204:205], v11 offset:19968
ds_read_b64_tr_b16 a[206:207], v11 offset:20480
s_add_u32 m0, s60, 122880
s_nop 0
buffer_load_dwordx4 v6, s[28:31], s58 offen offset:1024 lds
v_mfma_f32_16x16x32_bf16 v[24:27], a[68:71], v[16:19], v[24:27]
ds_read_b64_tr_b16 a[208:209], v11 offset:20992
v_mfma_f32_16x16x32_bf16 v[20:23], a[72:75], v[16:19], v[20:23]
ds_read_b64_tr_b16 a[210:211], v11 offset:21504
ds_read_b64_tr_b16 a[212:213], v11 offset:22016
v_mfma_f32_16x16x32_bf16 v[24:27], a[76:79], v[16:19], v[24:27]
ds_read_b64_tr_b16 a[214:215], v11 offset:22528
s_waitcnt vmcnt(8)
s_waitcnt lgkmcnt(0)
s_barrier
ds_read_b64_tr_b16 a[96:97], v9 offset:49152
v_mfma_f32_16x16x32_bf16 v[28:31], a[192:195], v[16:19], v[28:31]
ds_read_b64_tr_b16 a[98:99], v9 offset:53248
ds_read_b64_tr_b16 a[100:101], v10 offset:49152
v_mfma_f32_16x16x32_bf16 v[28:31], a[196:199], v[16:19], v[28:31]
ds_read_b64_tr_b16 a[102:103], v10 offset:53248
ds_read_b64_tr_b16 a[104:105], v9 offset:57344
v_mfma_f32_16x16x32_bf16 v[28:31], a[200:203], v[16:19], v[28:31]
ds_read_b64_tr_b16 a[106:107], v9 offset:61440
ds_read_b64_tr_b16 a[108:109], v10 offset:57344
v_mfma_f32_16x16x32_bf16 v[28:31], a[204:207], v[16:19], v[28:31]
ds_read_b64_tr_b16 a[110:111], v10 offset:61440
v_mfma_f32_16x16x32_bf16 v[20:23], a[80:83], v[16:19], v[20:23]
v_mfma_f32_16x16x32_bf16 v[28:31], a[208:211], v[16:19], v[28:31]
v_mfma_f32_16x16x32_bf16 v[24:27], a[84:87], v[16:19], v[24:27]
v_mfma_f32_16x16x32_bf16 v[20:23], a[88:91], v[16:19], v[20:23]
v_mfma_f32_16x16x32_bf16 v[28:31], a[212:215], v[16:19], v[28:31]
v_mfma_f32_16x16x32_bf16 v[24:27], a[92:95], v[16:19], v[24:27]
s_waitcnt vmcnt(4)
s_waitcnt lgkmcnt(0)
s_barrier
ds_read_b64_tr_b16 a[112:113], v9 offset:0
ds_read_b64_tr_b16 a[114:115], v9 offset:4096
ds_read_b64_tr_b16 a[116:117], v10 offset:0
ds_read_b64_tr_b16 a[118:119], v10 offset:4096
ds_read_b64_tr_b16 a[120:121], v9 offset:8192
ds_read_b64_tr_b16 a[122:123], v9 offset:12288
ds_read_b64_tr_b16 a[124:125], v10 offset:8192
ds_read_b64_tr_b16 a[126:127], v10 offset:12288
v_mfma_f32_16x16x32_bf16 v[20:23], a[96:99], v[16:19], v[20:23]
v_mfma_f32_16x16x32_bf16 v[24:27], a[100:103], v[16:19], v[24:27]
v_mfma_f32_16x16x32_bf16 v[20:23], a[104:107], v[16:19], v[20:23]
v_mfma_f32_16x16x32_bf16 v[24:27], a[108:111], v[16:19], v[24:27]
s_waitcnt vmcnt(0)
s_waitcnt lgkmcnt(0)
s_barrier
ds_read_b64_tr_b16 a[128:129], v9 offset:16384
buffer_load_dword v249, v238, s[36:39], 0 offen sc1
ds_read_b64_tr_b16 a[130:131], v9 offset:20480
ds_read_b64_tr_b16 a[132:133], v10 offset:16384
ds_read_b64_tr_b16 a[134:135], v10 offset:20480
ds_read_b64_tr_b16 a[136:137], v9 offset:24576
ds_read_b64_tr_b16 a[138:139], v9 offset:28672
ds_read_b64_tr_b16 a[140:141], v10 offset:24576
ds_read_b64_tr_b16 a[142:143], v10 offset:28672
v_mfma_f32_16x16x32_bf16 v[20:23], a[112:115], v[16:19], v[20:23]
v_mfma_f32_16x16x32_bf16 v[24:27], a[116:119], v[16:19], v[24:27]
v_mfma_f32_16x16x32_bf16 v[20:23], a[120:123], v[16:19], v[20:23]
v_mfma_f32_16x16x32_bf16 v[24:27], a[124:127], v[16:19], v[24:27]
s_waitcnt lgkmcnt(0)
v_mfma_f32_16x16x32_bf16 v[20:23], a[128:131], v[16:19], v[20:23]
v_mfma_f32_16x16x32_bf16 v[24:27], a[132:135], v[16:19], v[24:27]
v_mfma_f32_16x16x32_bf16 v[20:23], a[136:139], v[16:19], v[20:23]
v_mfma_f32_16x16x32_bf16 v[24:27], a[140:143], v[16:19], v[24:27]
s_branch L_main
L_p2:
s_sub_u32 s66, s45, 9
v_lshrrev_b32 v56, 3, v0
v_bfe_u32 v57, v0, 1, 2
v_bfe_u32 v58, v0, 4, 2
v_xor_b32 v57, v57, v58
v_and_b32 v58, 1, v0
v_lshlrev_b32 v58, 4, v58
v_lshl_add_u32 v57, v57, 5, v58
v_mul_u32_u24 v56, 1152, v56
s_lshl_b32 s52, s66, 7
v_add3_u32 v96, v56, v57, s52
s_mov_b32 s24, s8
s_and_b32 s25, s9, 0xffff
s_mov_b32 s26, 663552
s_mov_b32 s27, 0x20000
s_mov_b32 s36, s18
s_and_b32 s37, s19, 0xffff
s_mov_b32 s38, 16777216
s_mov_b32 s39, 0x20000
s_getreg_b32 s50, hwreg(HW_REG_XCC_ID)
v_and_b32 v2, 15, v0
v_bfe_u32 v3, v0, 4, 2
v_lshlrev_b32 v4, 4, v1
s_mov_b32 s64, 0xc0135761
s_mov_b32 s65, 0xbdd2d3e8
s_mov_b32 s28, s10
s_and_b32 s29, s11, 0xffff
s_mov_b32 s30, 5308416
s_mov_b32 s31, 0x20000
s_mov_b32 s32, s12
s_and_b32 s33, s13, 0xffff
s_mov_b32 s34, 5308416
s_mov_b32 s35, 0x20000
s_mov_b32 s40, s14
s_and_b32 s41, s15, 0xffff
s_mov_b32 s42, 589824
s_mov_b32 s43, 0x20000
s_lshr_b32 s46, s45, 2
s_and_b32 s47, s45, 3
v_lshlrev_b32 v13, 3, v1
s_lshl_b32 s60, s48, 11
s_lshl_b32 s52, s48, 3
v_add_u32 v56, s52, v3
v_lshrrev_b32 v57, 1, v2
v_xor_b32 v57, v57, v3
v_and_b32 v58, 1, v2
v_lshlrev_b32 v58, 4, v58
v_lshl_add_u32 v57, v57, 5, v58
v_xor_b32 v58, 128, v57
s_mul_i32 s53, s44, 1152
s_lshl_b32 s54, s47, 8
s_add_u32 s53, s53, s54
v_mul_u32_u24 v5, 9216, v56
v_add_u32 v5, s53, v5
v_add_u32 v6, 35840, v5
v_add_u32 v5, v5, v57
v_add_u32 v6, v6, v58
s_mul_i32 s53, s44, 663552
s_add_u32 s53, s53, s54
v_mul_u32_u24 v7, 1152, v56
v_add_u32 v7, s53, v7
v_add_u32 v8, 3584, v7
v_add_u32 v7, v7, v57
v_add_u32 v8, v8, v58
s_waitcnt lgkmcnt(0)
s_add_u32 s49, s49, 1
v_mov_b32 v14, s49
s_lshl_b32 s52, s2, 7
s_add_u32 s52, s52, 4096
v_mov_b32 v52, s52
v_mov_b32 v54, s49
v_mov_b32 v55, s50
s_cmp_lg_u32 s48, 0
s_cbranch_scc1 L_13
buffer_store_dwordx2 v[54:55], v52, s[36:39], 0 offen sc1
L_13:
s_mov_b32 s20, s4
s_and_b32 s21, s5, 0xffff
s_mov_b32 s22, 589824
s_mov_b32 s23, 0x20000
s_lshl_b32 s52, s44, 2
s_add_u32 s52, s52, s48
s_mul_i32 s53, s52, 18432
s_add_u32 s53, s53, 1048576
v_add_u32 v98, s53, v4
s_lshl_b32 s54, s66, 11
s_add_u32 s54, s54, s53
v_lshlrev_b32 v56, 7, v2
v_add_u32 v56, s54, v56
s_lshl_b32 s53, s44, 8
s_add_u32 s53, s53, 65536
v_min_u32 v57, 35, v1
v_lshlrev_b32 v57, 2, v57
v_add_u32 v99, s53, v57
v_cmp_le_u32 vcc, 16, v1
s_mul_i32 s53, s52, 18432
s_lshl_b32 s54, s66, 7
v_cndmask_b32 v56, v56, v99, vcc
buffer_load_dword v60, v56, s[36:39], 0 offen
s_add_u32 s53, s53, s54
v_mul_u32_u24 v56, 1152, v2
v_lshlrev_b32 v57, 3, v3
v_add3_u32 v97, v56, v57, s53
s_mul_i32 s53, s44, 81920
s_add_u32 s53, s53, 2097152
s_lshl_b32 s54, s66, 11
s_add_u32 s54, s54, s53
s_mul_i32 s52, s48, 18432
s_add_u32 s54, s54, s52
s_add_u32 s54, s54, 4608
v_add_u32 v100, s54, v4
s_lshl_b32 s54, s66, 9
s_add_u32 s54, s54, s53
s_lshl_b32 s52, s48, 7
s_add_u32 s54, s54, s52
v_lshlrev_b32 v56, 3, v2
v_add_u32 v101, s54, v56
s_mul_i32 s53, s44, 9
s_add_u32 s53, s53, s66
s_lshl_b32 s53, s53, 7
s_add_u32 s53, s53, 73728
v_mov_b32 v102, s53
v_lshrrev_b32 v56, 2, v1
v_bfe_u32 v57, v1, 3, 2
v_and_b32 v58, 3, v1
v_lshlrev_b32 v58, 3, v58
v_lshl_add_u32 v57, v57, 5, v58
v_lshl_add_u32 v104, v56, 7, v57
v_xor_b32 v105, 32, v104
v_xor_b32 v106, 64, v104
v_xor_b32 v107, 96, v104
v_add_u32 v108, 36864, v104
v_add_u32 v109, 36864, v105
v_add_u32 v110, 36864, v106
v_add_u32 v111, 36864, v107
buffer_load_dword v60, v102, s[36:39], 0 offen
v_lshrrev_b32 v56, 3, v1
v_and_b32 v57, 7, v1
v_lshlrev_b32 v57, 7, v57
v_mul_u32_u24 v225, 9216, v56
v_add_u32 v225, v225, v57
v_mul_u32_u24 v254, 1152, v56
v_add_u32 v254, v254, v57
s_sub_u32 s51, s45, 9
s_lshl_b32 s51, s51, 2
s_add_u32 s51, s51, s48
buffer_load_dwordx2 v[212:213], v97, s[20:23], 0 offen offset:0
buffer_load_dwordx2 v[214:215], v97, s[20:23], 0 offen offset:32
buffer_load_dwordx2 v[216:217], v97, s[20:23], 0 offen offset:64
buffer_load_dwordx2 v[218:219], v97, s[20:23], 0 offen offset:96
v_lshrrev_b32 v56, 2, v1
v_and_b32 v57, 3, v1
v_lshlrev_b32 v57, 3, v57
v_lshl_add_u32 v11, v56, 5, v57
v_add_u32 v15, 98304, v11
v_and_b32 v58, 7, v56
s_lshl_b32 s52, s48, 1
v_xor_b32 v58, s52, v58
v_lshl_add_u32 v58, v58, 5, v57
v_lshl_add_u32 v58, v56, 8, v58
v_add_u32 v9, 98304, v58
v_xor_b32 v58, 32, v58
v_add_u32 v10, 98304, v58
v_subrev_u32 v242, 16384, v9
v_subrev_u32 v243, 16384, v10
v_add_u32 v224, 4608, v4
v_add_u32 v12, 41472, v4
v_mov_b32 v16, 0x3f803f80
v_mov_b32 v17, 0x3f803f80
v_mov_b32 v18, 0x3f803f80
v_mov_b32 v19, 0x3f803f80
s_lshl_b32 s75, s48, 12
s_mul_i32 s52, s48, 18432
v_add_u32 v232, s52, v224
s_add_u32 s71, s52, 16384
s_mul_i32 s78, s46, 81920
s_add_u32 s78, s78, 2097152
s_lshl_b32 s55, s44, 3
s_add_u32 s56, s55, s47
s_mul_i32 s81, s56, 18432
s_add_u32 s81, s81, 3145728
s_lshl_b32 s72, s48, 9
s_add_u32 s72, s72, 16384
s_add_u32 s55, s55, s46
s_mul_i32 s79, s55, 73728
s_add_u32 s79, s79, 5242880
s_lshr_b32 s53, s47, 1
s_lshl_b32 s53, s53, 10
s_add_u32 s53, s53, s71
s_add_u32 s53, s53, s79
s_and_b32 s54, s47, 1
s_lshl_b32 s54, s54, 3
s_add_u32 s54, s54, s53
v_add_u32 v229, s54, v4
s_lshl_b32 s52, s47, 2
s_add_u32 s52, s52, s48
s_lshl_b32 s54, s52, 10
s_add_u32 s54, s54, s79
v_add_u32 v228, s54, v4
s_lshl_b32 s55, s55, 10
s_add_u32 s55, s55, 196608
v_lshlrev_b32 v56, 2, v2
v_add_u32 v231, s55, v56
s_lshl_b32 s52, s52, 2
s_add_u32 s52, s52, s55
v_mov_b32 v230, s52
v_and_b32 v56, 3, v1
s_lshl_b32 s52, s44, 9
s_add_u32 s52, s52, 163840
v_lshlrev_b32 v57, 7, v56
v_add_u32 v239, s52, v57
s_lshl_b32 s52, s46, 5
s_add_u32 s52, s52, s44
s_lshl_b32 s52, s52, 7
s_add_u32 s52, s52, 4096
v_lshlrev_b32 v57, 10, v56
v_add_u32 v240, s52, v57
s_mul_i32 s52, s46, 1152
s_add_u32 s52, s52, 73728
v_min_u32 v57, 8, v1
v_lshlrev_b32 v57, 7, v57
v_add_u32 v238, s52, v57
s_and_b32 s53, s44, 1
s_lshl_b32 s53, s53, 1
s_add_u32 s53, s53, s48
s_lshl_b32 s54, s47, 2
s_add_u32 s53, s53, s54
s_lshr_b32 s54, s47, 1
s_add_u32 s54, s54, 16
s_cmp_ge_u32 s48, 2
s_cselect_b32 s53, s54, s53
s_lshl_b32 s53, s53, 10
s_lshr_b32 s52, s44, 1
s_mul_i32 s52, s52, 18432
s_add_u32 s52, s52, s53
v_add_u32 v233, s52, v224
s_mul_i32 s80, s45, 147456
s_add_u32 s80, s80, 10485760
s_mul_i32 s52, s44, 4608
s_add_u32 s52, s52, s80
s_add_u32 s53, s70, s52
v_add_u32 v234, s53, v4
s_mul_i32 s53, s48, 36864
s_add_u32 s53, s53, s52
s_add_u32 s53, s53, 4096
v_add_u32 v235, s53, v13
s_lshl_b32 s52, s45, 10
s_add_u32 s52, s52, 131072
v_and_b32 v56, 7, v1
v_lshlrev_b32 v56, 7, v56
v_lshl_add_u32 v56, v3, 2, v56
v_add_u32 v237, s52, v56
s_lshl_b32 s53, s44, 5
s_add_u32 s53, s53, s48
s_lshl_b32 s53, s53, 2
s_add_u32 s52, s52, s53
v_mov_b32 v236, s52
v_mul_u32_u24 v253, 1152, v2
v_lshl_add_u32 v253, v3, 3, v253
v_mov_b32 v52, -1
v_mov_b32 v53, -1
v_mov_b32 v54, -1
v_mov_b32 v55, -1
s_mov_b32 s52, 0
buffer_store_dwordx4 v[52:55], v234, s[36:39], s52 offen sc1
s_mov_b32 s52, 36864
buffer_store_dwordx4 v[52:55], v234, s[36:39], s52 offen sc1
s_mov_b32 s52, 73728
buffer_store_dwordx4 v[52:55], v234, s[36:39], s52 offen sc1
s_mov_b32 s52, 110592
buffer_store_dwordx4 v[52:55], v234, s[36:39], s52 offen sc1
buffer_store_dwordx2 v[52:53], v235, s[36:39], 0 offen sc1
s_nop 0
s_add_u32 m0, s70, 0
s_mov_b32 s67, 0
buffer_load_dwordx4 v96, s[24:27], s67 offen lds
s_add_u32 m0, s70, 4096
s_mov_b32 s67, 36864
buffer_load_dwordx4 v96, s[24:27], s67 offen lds
s_add_u32 m0, s70, 8192
s_mov_b32 s67, 73728
buffer_load_dwordx4 v96, s[24:27], s67 offen lds
s_add_u32 m0, s70, 12288
s_mov_b32 s67, 110592
buffer_load_dwordx4 v96, s[24:27], s67 offen lds
s_add_u32 m0, s70, 16384
s_mov_b32 s67, 147456
buffer_load_dwordx4 v96, s[24:27], s67 offen lds
s_add_u32 m0, s70, 20480
s_mov_b32 s67, 184320
buffer_load_dwordx4 v96, s[24:27], s67 offen lds
s_add_u32 m0, s70, 24576
s_mov_b32 s67, 221184
buffer_load_dwordx4 v96, s[24:27], s67 offen lds
s_waitcnt vmcnt(4)
s_barrier
ds_read_b64_tr_b16 a[0:1], v104 offset:0
s_add_u32 m0, s70, 28672
s_mov_b32 s67, 258048
buffer_load_dwordx4 v96, s[24:27], s67 offen lds
ds_read_b64_tr_b16 a[2:3], v104 offset:2048
ds_read_b64_tr_b16 a[4:5], v105 offset:0
ds_read_b64_tr_b16 a[6:7], v105 offset:2048
ds_read_b64_tr_b16 a[8:9], v106 offset:0
ds_read_b64_tr_b16 a[10:11], v106 offset:2048
ds_read_b64_tr_b16 a[12:13], v107 offset:0
ds_read_b64_tr_b16 a[14:15], v107 offset:2048
ds_read_b64_tr_b16 a[16:17], v104 offset:4096
s_add_u32 m0, s70, 32768
s_mov_b32 s67, 294912
buffer_load_dwordx4 v96, s[24:27], s67 offen lds
ds_read_b64_tr_b16 a[18:19], v104 offset:6144
ds_read_b64_tr_b16 a[20:21], v105 offset:4096
ds_read_b64_tr_b16 a[22:23], v105 offset:6144
ds_read_b64_tr_b16 a[24:25], v106 offset:4096
ds_read_b64_tr_b16 a[26:27], v106 offset:6144
ds_read_b64_tr_b16 a[28:29], v107 offset:4096
ds_read_b64_tr_b16 a[30:31], v107 offset:6144
ds_read_b64_tr_b16 a[32:33], v104 offset:8192
s_add_u32 m0, s70, 36864
s_mov_b32 s67, 331776
buffer_load_dwordx4 v96, s[24:27], s67 offen lds
ds_read_b64_tr_b16 a[34:35], v104 offset:10240
ds_read_b64_tr_b16 a[36:37], v105 offset:8192
ds_read_b64_tr_b16 a[38:39], v105 offset:10240
ds_read_b64_tr_b16 a[40:41], v106 offset:8192
ds_read_b64_tr_b16 a[42:43], v106 offset:10240
ds_read_b64_tr_b16 a[44:45], v107 offset:8192
ds_read_b64_tr_b16 a[46:47], v107 offset:10240
s_waitcnt vmcnt(4)
s_barrier
ds_read_b64_tr_b16 a[48:49], v104 offset:12288
s_add_u32 m0, s70, 40960
s_mov_b32 s67, 368640
buffer_load_dwordx4 v96, s[24:27], s67 offen lds
ds_read_b64_tr_b16 a[50:51], v104 offset:14336
ds_read_b64_tr_b16 a[52:53], v105 offset:12288
ds_read_b64_tr_b16 a[54:55], v105 offset:14336
ds_read_b64_tr_b16 a[56:57], v106 offset:12288
ds_read_b64_tr_b16 a[58:59], v106 offset:14336
ds_read_b64_tr_b16 a[60:61], v107 offset:12288
ds_read_b64_tr_b16 a[62:63], v107 offset:14336
ds_read_b64_tr_b16 a[64:65], v104 offset:16384
s_add_u32 m0, s70, 45056
s_mov_b32 s67, 405504
buffer_load_dwordx4 v96, s[24:27], s67 offen lds
ds_read_b64_tr_b16 a[66:67], v104 offset:18432
ds_read_b64_tr_b16 a[68:69], v105 offset:16384
ds_read_b64_tr_b16 a[70:71], v105 offset:18432
ds_read_b64_tr_b16 a[72:73], v106 offset:16384
ds_read_b64_tr_b16 a[74:75], v106 offset:18432
ds_read_b64_tr_b16 a[76:77], v107 offset:16384
ds_read_b64_tr_b16 a[78:79], v107 offset:18432
ds_read_b64_tr_b16 a[80:81], v104 offset:20480
s_add_u32 m0, s70, 49152
s_mov_b32 s67, 442368
buffer_load_dwordx4 v96, s[24:27], s67 offen lds
ds_read_b64_tr_b16 a[82:83], v104 offset:22528
ds_read_b64_tr_b16 a[84:85], v105 offset:20480
ds_read_b64_tr_b16 a[86:87], v105 offset:22528
ds_read_b64_tr_b16 a[88:89], v106 offset:20480
ds_read_b64_tr_b16 a[90:91], v106 offset:22528
ds_read_b64_tr_b16 a[92:93], v107 offset:20480
ds_read_b64_tr_b16 a[94:95], v107 offset:22528
s_waitcnt vmcnt(4)
s_barrier
ds_read_b64_tr_b16 a[96:97], v104 offset:24576
s_add_u32 m0, s70, 53248
s_mov_b32 s67, 479232
buffer_load_dwordx4 v96, s[24:27], s67 offen lds
ds_read_b64_tr_b16 a[98:99], v104 offset:26624
ds_read_b64_tr_b16 a[100:101], v105 offset:24576
ds_read_b64_tr_b16 a[102:103], v105 offset:26624
ds_read_b64_tr_b16 a[104:105], v106 offset:24576
ds_read_b64_tr_b16 a[106:107], v106 offset:26624
ds_read_b64_tr_b16 a[108:109], v107 offset:24576
ds_read_b64_tr_b16 a[110:111], v107 offset:26624
ds_read_b64_tr_b16 a[112:113], v104 offset:28672
s_add_u32 m0, s70, 57344
s_mov_b32 s67, 516096
buffer_load_dwordx4 v96, s[24:27], s67 offen lds
ds_read_b64_tr_b16 a[114:115], v104 offset:30720
ds_read_b64_tr_b16 a[116:117], v105 offset:28672
ds_read_b64_tr_b16 a[118:119], v105 offset:30720
ds_read_b64_tr_b16 a[120:121], v106 offset:28672
ds_read_b64_tr_b16 a[122:123], v106 offset:30720
ds_read_b64_tr_b16 a[124:125], v107 offset:28672
ds_read_b64_tr_b16 a[126:127], v107 offset:30720
ds_read_b64_tr_b16 a[128:129], v104 offset:32768
s_add_u32 m0, s70, 61440
s_mov_b32 s67, 552960
buffer_load_dwordx4 v96, s[24:27], s67 offen lds
ds_read_b64_tr_b16 a[130:131], v104 offset:34816
ds_read_b64_tr_b16 a[132:133], v105 offset:32768
ds_read_b64_tr_b16 a[134:135], v105 offset:34816
ds_read_b64_tr_b16 a[136:137], v106 offset:32768
ds_read_b64_tr_b16 a[138:139], v106 offset:34816
ds_read_b64_tr_b16 a[140:141], v107 offset:32768
ds_read_b64_tr_b16 a[142:143], v107 offset:34816
s_waitcnt vmcnt(4)
s_barrier
ds_read_b64_tr_b16 a[216:217], v108 offset:0
s_add_u32 m0, s70, 65536
s_mov_b32 s67, 589824
buffer_load_dwordx4 v96, s[24:27], s67 offen lds
ds_read_b64_tr_b16 a[218:219], v108 offset:2048
ds_read_b64_tr_b16 a[220:221], v109 offset:0
ds_read_b64_tr_b16 a[222:223], v109 offset:2048
ds_read_b64_tr_b16 a[224:225], v110 offset:0
ds_read_b64_tr_b16 a[226:227], v110 offset:2048
ds_read_b64_tr_b16 a[228:229], v111 offset:0
ds_read_b64_tr_b16 a[230:231], v111 offset:2048
ds_read_b64_tr_b16 a[232:233], v108 offset:4096
ds_read_b64_tr_b16 a[234:235], v108 offset:6144
ds_read_b64_tr_b16 a[236:237], v109 offset:4096
ds_read_b64_tr_b16 a[238:239], v109 offset:6144
ds_read_b64_tr_b16 a[240:241], v110 offset:4096
s_add_u32 m0, s70, 69632
s_mov_b32 s67, 626688
buffer_load_dwordx4 v96, s[24:27], s67 offen lds
ds_read_b64_tr_b16 a[242:243], v110 offset:6144
ds_read_b64_tr_b16 a[244:245], v111 offset:4096
ds_read_b64_tr_b16 a[246:247], v111 offset:6144
ds_read_b64_tr_b16 v[116:117], v108 offset:8192
ds_read_b64_tr_b16 v[118:119], v108 offset:10240
ds_read_b64_tr_b16 v[120:121], v109 offset:8192
ds_read_b64_tr_b16 v[122:123], v109 offset:10240
ds_read_b64_tr_b16 v[124:125], v110 offset:8192
ds_read_b64_tr_b16 v[126:127], v110 offset:10240
ds_read_b64_tr_b16 v[128:129], v111 offset:8192
ds_read_b64_tr_b16 v[130:131], v111 offset:10240
s_waitcnt vmcnt(3)
s_barrier
ds_read_b64_tr_b16 v[132:133], v108 offset:12288
ds_read_b64_tr_b16 v[134:135], v108 offset:14336
ds_read_b64_tr_b16 v[136:137], v109 offset:12288
ds_read_b64_tr_b16 v[138:139], v109 offset:14336
ds_read_b64_tr_b16 v[140:141], v110 offset:12288
ds_read_b64_tr_b16 v[142:143], v110 offset:14336
ds_read_b64_tr_b16 v[144:145], v111 offset:12288
ds_read_b64_tr_b16 v[146:147], v111 offset:14336
ds_read_b64_tr_b16 v[148:149], v108 offset:16384
ds_read_b64_tr_b16 v[150:151], v108 offset:18432
ds_read_b64_tr_b16 v[152:153], v109 offset:16384
ds_read_b64_tr_b16 v[154:155], v109 offset:18432
ds_read_b64_tr_b16 v[156:157], v110 offset:16384
ds_read_b64_tr_b16 v[158:159], v110 offset:18432
ds_read_b64_tr_b16 v[160:161], v111 offset:16384
ds_read_b64_tr_b16 v[162:163], v111 offset:18432
ds_read_b64_tr_b16 v[164:165], v108 offset:20480
ds_read_b64_tr_b16 v[166:167], v108 offset:22528
ds_read_b64_tr_b16 v[168:169], v109 offset:20480
ds_read_b64_tr_b16 v[170:171], v109 offset:22528
ds_read_b64_tr_b16 v[172:173], v110 offset:20480
ds_read_b64_tr_b16 v[174:175], v110 offset:22528
ds_read_b64_tr_b16 v[176:177], v111 offset:20480
ds_read_b64_tr_b16 v[178:179], v111 offset:22528
s_waitcnt vmcnt(0)
s_barrier
ds_read_b64_tr_b16 v[180:181], v108 offset:24576
ds_read_b64_tr_b16 v[182:183], v108 offset:26624
ds_read_b64_tr_b16 v[184:185], v109 offset:24576
ds_read_b64_tr_b16 v[186:187], v109 offset:26624
ds_read_b64_tr_b16 v[188:189], v110 offset:24576
ds_read_b64_tr_b16 v[190:191], v110 offset:26624
ds_read_b64_tr_b16 v[192:193], v111 offset:24576
ds_read_b64_tr_b16 v[194:195], v111 offset:26624
ds_read_b64_tr_b16 v[196:197], v108 offset:28672
ds_read_b64_tr_b16 v[198:199], v108 offset:30720
ds_read_b64_tr_b16 v[200:201], v109 offset:28672
ds_read_b64_tr_b16 v[202:203], v109 offset:30720
ds_read_b64_tr_b16 v[204:205], v110 offset:28672
ds_read_b64_tr_b16 v[206:207], v110 offset:30720
ds_read_b64_tr_b16 v[208:209], v111 offset:28672
ds_read_b64_tr_b16 v[210:211], v111 offset:30720
ds_read_b64_tr_b16 v[32:33], v108 offset:32768
ds_read_b64_tr_b16 v[34:35], v108 offset:34816
ds_read_b64_tr_b16 v[36:37], v109 offset:32768
ds_read_b64_tr_b16 v[38:39], v109 offset:34816
ds_read_b64_tr_b16 v[40:41], v110 offset:32768
ds_read_b64_tr_b16 v[42:43], v110 offset:34816
ds_read_b64_tr_b16 v[44:45], v111 offset:32768
ds_read_b64_tr_b16 v[46:47], v111 offset:34816
v_lshlrev_b32 v80, 16, v212
v_and_b32 v81, 0xffff0000, v212
v_lshlrev_b32 v82, 16, v213
v_and_b32 v83, 0xffff0000, v213
v_lshlrev_b32 v84, 16, v214
v_and_b32 v85, 0xffff0000, v214
v_lshlrev_b32 v86, 16, v215
v_and_b32 v87, 0xffff0000, v215
v_lshlrev_b32 v88, 16, v216
v_and_b32 v89, 0xffff0000, v216
v_lshlrev_b32 v90, 16, v217
v_and_b32 v91, 0xffff0000, v217
v_lshlrev_b32 v92, 16, v218
v_and_b32 v93, 0xffff0000, v218
v_lshlrev_b32 v94, 16, v219
v_and_b32 v95, 0xffff0000, v219
s_movk_i32 s67, 4096
s_movk_i32 s68, 8192
s_movk_i32 s69, 12288
s_movk_i32 s52, 16384
s_waitcnt lgkmcnt(0)
s_mov_b32 s61, 0x40000
L_poll_14:
buffer_load_dword v52, v99, s[36:39], 0 offen sc1
s_sub_u32 s61, s61, 1
s_cbranch_scc1 L_polld_15
s_waitcnt vmcnt(0)
v_cmp_ne_u32 vcc, s49, v52
s_cbranch_vccnz L_poll_14
L_polld_15:
buffer_load_dwordx4 a[144:147], v98, s[36:39], 0 offen offset:0 sc1
buffer_load_dwordx4 a[148:151], v98, s[36:39], 0 offen offset:1024 sc1
buffer_load_dwordx4 a[152:155], v98, s[36:39], 0 offen offset:2048 sc1
buffer_load_dwordx4 a[156:159], v98, s[36:39], 0 offen offset:3072 sc1
buffer_load_dwordx4 a[160:163], v98, s[36:39], s67 offen offset:0 sc1
buffer_load_dwordx4 a[164:167], v98, s[36:39], s67 offen offset:1024 sc1
s_waitcnt vmcnt(5)
v_mfma_f32_16x16x32_bf16 v[80:83], a[0:3], a[144:147], v[80:83]
buffer_load_dwordx4 a[168:171], v98, s[36:39], s67 offen offset:2048 sc1
v_mfma_f32_16x16x32_bf16 v[84:87], a[4:7], a[144:147], v[84:87]
v_mfma_f32_16x16x32_bf16 v[88:91], a[8:11], a[144:147], v[88:91]
v_mfma_f32_16x16x32_bf16 v[92:95], a[12:15], a[144:147], v[92:95]
s_waitcnt vmcnt(5)
v_mfma_f32_16x16x32_bf16 v[80:83], a[16:19], a[148:151], v[80:83]
buffer_load_dwordx4 a[172:175], v98, s[36:39], s67 offen offset:3072 sc1
v_mfma_f32_16x16x32_bf16 v[84:87], a[20:23], a[148:151], v[84:87]
v_mfma_f32_16x16x32_bf16 v[88:91], a[24:27], a[148:151], v[88:91]
v_mfma_f32_16x16x32_bf16 v[92:95], a[28:31], a[148:151], v[92:95]
s_waitcnt vmcnt(5)
v_mfma_f32_16x16x32_bf16 v[80:83], a[32:35], a[152:155], v[80:83]
buffer_load_dwordx4 a[176:179], v98, s[36:39], s68 offen offset:0 sc1
v_mfma_f32_16x16x32_bf16 v[84:87], a[36:39], a[152:155], v[84:87]
v_mfma_f32_16x16x32_bf16 v[88:91], a[40:43], a[152:155], v[88:91]
v_mfma_f32_16x16x32_bf16 v[92:95], a[44:47], a[152:155], v[92:95]
s_waitcnt vmcnt(5)
v_mfma_f32_16x16x32_bf16 v[80:83], a[48:51], a[156:159], v[80:83]
buffer_load_dwordx4 a[180:183], v98, s[36:39], s68 offen offset:1024 sc1
v_mfma_f32_16x16x32_bf16 v[84:87], a[52:55], a[156:159], v[84:87]
v_mfma_f32_16x16x32_bf16 v[88:91], a[56:59], a[156:159], v[88:91]
v_mfma_f32_16x16x32_bf16 v[92:95], a[60:63], a[156:159], v[92:95]
s_waitcnt vmcnt(5)
v_mfma_f32_16x16x32_bf16 v[80:83], a[64:67], a[160:163], v[80:83]
buffer_load_dwordx4 a[184:187], v98, s[36:39], s68 offen offset:2048 sc1
v_mfma_f32_16x16x32_bf16 v[84:87], a[68:71], a[160:163], v[84:87]
v_mfma_f32_16x16x32_bf16 v[88:91], a[72:75], a[160:163], v[88:91]
v_mfma_f32_16x16x32_bf16 v[92:95], a[76:79], a[160:163], v[92:95]
s_waitcnt vmcnt(5)
v_mfma_f32_16x16x32_bf16 v[80:83], a[80:83], a[164:167], v[80:83]
buffer_load_dwordx4 a[188:191], v98, s[36:39], s68 offen offset:3072 sc1
v_mfma_f32_16x16x32_bf16 v[84:87], a[84:87], a[164:167], v[84:87]
v_mfma_f32_16x16x32_bf16 v[88:91], a[88:91], a[164:167], v[88:91]
v_mfma_f32_16x16x32_bf16 v[92:95], a[92:95], a[164:167], v[92:95]
s_waitcnt vmcnt(5)
v_mfma_f32_16x16x32_bf16 v[80:83], a[96:99], a[168:171], v[80:83]
buffer_load_dwordx4 a[192:195], v98, s[36:39], s69 offen offset:0 sc1
v_mfma_f32_16x16x32_bf16 v[84:87], a[100:103], a[168:171], v[84:87]
v_mfma_f32_16x16x32_bf16 v[88:91], a[104:107], a[168:171], v[88:91]
v_mfma_f32_16x16x32_bf16 v[92:95], a[108:111], a[168:171], v[92:95]
s_waitcnt vmcnt(5)
v_mfma_f32_16x16x32_bf16 v[80:83], a[112:115], a[172:175], v[80:83]
buffer_load_dwordx4 a[196:199], v98, s[36:39], s69 offen offset:1024 sc1
v_mfma_f32_16x16x32_bf16 v[84:87], a[116:119], a[172:175], v[84:87]
v_mfma_f32_16x16x32_bf16 v[88:91], a[120:123], a[172:175], v[88:91]
v_mfma_f32_16x16x32_bf16 v[92:95], a[124:127], a[172:175], v[92:95]
s_waitcnt vmcnt(5)
v_mfma_f32_16x16x32_bf16 v[80:83], a[128:131], a[176:179], v[80:83]
buffer_load_dwordx4 a[200:203], v98, s[36:39], s69 offen offset:2048 sc1
v_mfma_f32_16x16x32_bf16 v[84:87], a[132:135], a[176:179], v[84:87]
v_mfma_f32_16x16x32_bf16 v[88:91], a[136:139], a[176:179], v[88:91]
v_mfma_f32_16x16x32_bf16 v[92:95], a[140:143], a[176:179], v[92:95]
s_waitcnt vmcnt(5)
v_mfma_f32_16x16x32_bf16 v[80:83], a[216:219], a[180:183], v[80:83]
buffer_load_dwordx4 a[204:207], v98, s[36:39], s69 offen offset:3072 sc1
v_mfma_f32_16x16x32_bf16 v[84:87], a[220:223], a[180:183], v[84:87]
v_mfma_f32_16x16x32_bf16 v[88:91], a[224:227], a[180:183], v[88:91]
v_mfma_f32_16x16x32_bf16 v[92:95], a[228:231], a[180:183], v[92:95]
s_waitcnt vmcnt(5)
v_mfma_f32_16x16x32_bf16 v[80:83], a[232:235], a[184:187], v[80:83]
buffer_load_dwordx4 a[208:211], v98, s[36:39], s52 offen offset:0 sc1
v_mfma_f32_16x16x32_bf16 v[84:87], a[236:239], a[184:187], v[84:87]
v_mfma_f32_16x16x32_bf16 v[88:91], a[240:243], a[184:187], v[88:91]
v_mfma_f32_16x16x32_bf16 v[92:95], a[244:247], a[184:187], v[92:95]
s_waitcnt vmcnt(5)
v_mfma_f32_16x16x32_bf16 v[80:83], v[116:119], a[188:191], v[80:83]
buffer_load_dwordx4 a[212:215], v98, s[36:39], s52 offen offset:1024 sc1
v_mfma_f32_16x16x32_bf16 v[84:87], v[120:123], a[188:191], v[84:87]
v_mfma_f32_16x16x32_bf16 v[88:91], v[124:127], a[188:191], v[88:91]
v_mfma_f32_16x16x32_bf16 v[92:95], v[128:131], a[188:191], v[92:95]
s_waitcnt vmcnt(5)
v_mfma_f32_16x16x32_bf16 v[80:83], v[132:135], a[192:195], v[80:83]
v_mfma_f32_16x16x32_bf16 v[84:87], v[136:139], a[192:195], v[84:87]
v_mfma_f32_16x16x32_bf16 v[88:91], v[140:143], a[192:195], v[88:91]
v_mfma_f32_16x16x32_bf16 v[92:95], v[144:147], a[192:195], v[92:95]
s_waitcnt vmcnt(4)
v_mfma_f32_16x16x32_bf16 v[80:83], v[148:151], a[196:199], v[80:83]
v_mfma_f32_16x16x32_bf16 v[84:87], v[152:155], a[196:199], v[84:87]
v_mfma_f32_16x16x32_bf16 v[88:91], v[156:159], a[196:199], v[88:91]
v_mfma_f32_16x16x32_bf16 v[92:95], v[160:163], a[196:199], v[92:95]
s_waitcnt vmcnt(3)
v_mfma_f32_16x16x32_bf16 v[80:83], v[164:167], a[200:203], v[80:83]
v_mfma_f32_16x16x32_bf16 v[84:87], v[168:171], a[200:203], v[84:87]
v_mfma_f32_16x16x32_bf16 v[88:91], v[172:175], a[200:203], v[88:91]
v_mfma_f32_16x16x32_bf16 v[92:95], v[176:179], a[200:203], v[92:95]
s_waitcnt vmcnt(2)
v_mfma_f32_16x16x32_bf16 v[80:83], v[180:183], a[204:207], v[80:83]
v_mfma_f32_16x16x32_bf16 v[84:87], v[184:187], a[204:207], v[84:87]
v_mfma_f32_16x16x32_bf16 v[88:91], v[188:191], a[204:207], v[88:91]
v_mfma_f32_16x16x32_bf16 v[92:95], v[192:195], a[204:207], v[92:95]
s_waitcnt vmcnt(1)
v_mfma_f32_16x16x32_bf16 v[80:83], v[196:199], a[208:211], v[80:83]
v_mfma_f32_16x16x32_bf16 v[84:87], v[200:203], a[208:211], v[84:87]
v_mfma_f32_16x16x32_bf16 v[88:91], v[204:207], a[208:211], v[88:91]
v_mfma_f32_16x16x32_bf16 v[92:95], v[208:211], a[208:211], v[92:95]
s_waitcnt vmcnt(0)
v_mfma_f32_16x16x32_bf16 v[80:83], v[32:35], a[212:215], v[80:83]
v_mfma_f32_16x16x32_bf16 v[84:87], v[36:39], a[212:215], v[84:87]
v_mfma_f32_16x16x32_bf16 v[88:91], v[40:43], a[212:215], v[88:91]
v_mfma_f32_16x16x32_bf16 v[92:95], v[44:47], a[212:215], v[92:95]
s_nop 7
v_cvt_pk_bf16_f32 v68, v80, v81
v_cvt_pk_bf16_f32 v69, v82, v83
v_cvt_pk_bf16_f32 v70, v84, v85
v_cvt_pk_bf16_f32 v71, v86, v87
buffer_store_dwordx4 v[68:71], v100, s[36:39], 0 offen sc1
v_cvt_pk_bf16_f32 v72, v88, v89
v_cvt_pk_bf16_f32 v73, v90, v91
v_cvt_pk_bf16_f32 v74, v92, v93
v_cvt_pk_bf16_f32 v75, v94, v95
buffer_store_dwordx4 v[72:75], v100, s[36:39], 0 offen offset:1024 sc1
v_dot2_f32_bf16 v76, v68, v16, 0
v_dot2_f32_bf16 v77, v68, v68, 0
v_dot2_f32_bf16 v76, v69, v16, v76
v_dot2_f32_bf16 v77, v69, v69, v77
v_dot2_f32_bf16 v76, v70, v16, v76
v_dot2_f32_bf16 v77, v70, v70, v77
v_dot2_f32_bf16 v76, v71, v16, v76
v_dot2_f32_bf16 v77, v71, v71, v77
v_dot2_f32_bf16 v76, v72, v16, v76
v_dot2_f32_bf16 v77, v72, v72, v77
v_dot2_f32_bf16 v76, v73, v16, v76
v_dot2_f32_bf16 v77, v73, v73, v77
v_dot2_f32_bf16 v76, v74, v16, v76
v_dot2_f32_bf16 v77, v74, v74, v77
v_dot2_f32_bf16 v76, v75, v16, v76
v_dot2_f32_bf16 v77, v75, v75, v77
s_nop 2
v_mov_b32 v78, v76
v_mov_b32 v79, v77
s_nop 1
v_permlane32_swap_b32 v78, v76
v_permlane32_swap_b32 v79, v77
v_add_f32 v76, v76, v78
v_add_f32 v77, v77, v79
v_mov_b32 v78, v76
v_mov_b32 v79, v77
s_nop 1
v_permlane16_swap_b32 v78, v76
v_permlane16_swap_b32 v79, v77
v_add_f32 v76, v76, v78
v_add_f32 v77, v77, v79
buffer_store_dwordx2 v[76:77], v101, s[36:39], 0 offen sc1
buffer_load_dword v248, v239, s[36:39], 0 offen sc1
buffer_load_dwordx2 v[250:251], v240, s[36:39], 0 offen sc1
s_add_u32 m0, s60, 114688
s_mov_b32 s58, 0
buffer_load_dwordx4 v5, s[28:31], s58 offen lds
s_add_u32 m0, s60, 114688
s_nop 0
buffer_load_dwordx4 v6, s[28:31], s58 offen offset:1024 lds
s_add_u32 m0, s60, 122880
s_mov_b32 s58, 294912
buffer_load_dwordx4 v5, s[28:31], s58 offen lds
s_add_u32 m0, s60, 122880
s_nop 0
buffer_load_dwordx4 v6, s[28:31], s58 offen offset:1024 lds
s_add_u32 m0, s60, 131072
s_mov_b32 s58, 589824
buffer_load_dwordx4 v5, s[28:31], s58 offen lds
s_add_u32 m0, s60, 131072
s_nop 0
buffer_load_dwordx4 v6, s[28:31], s58 offen offset:1024 lds
s_add_u32 m0, s60, 139264
s_mov_b32 s58, 884736
buffer_load_dwordx4 v5, s[28:31], s58 offen lds
s_add_u32 m0, s60, 139264
s_nop 0
buffer_load_dwordx4 v6, s[28:31], s58 offen offset:1024 lds
s_add_u32 m0, s60, 147456
s_mov_b32 s58, 1179648
buffer_load_dwordx4 v5, s[28:31], s58 offen lds
s_add_u32 m0, s60, 147456
s_nop 0
buffer_load_dwordx4 v6, s[28:31], s58 offen offset:1024 lds
s_add_u32 m0, s60, 155648
s_mov_b32 s58, 1474560
buffer_load_dwordx4 v5, s[28:31], s58 offen lds
s_add_u32 m0, s60, 155648
s_nop 0
buffer_load_dwordx4 v6, s[28:31], s58 offen offset:1024 lds
s_waitcnt vmcnt(14)
s_barrier
s_cmp_lg_u32 s48, 0
s_cbranch_scc1 L_16
buffer_store_dword v14, v102, s[36:39], 0 offen sc1
L_16:
s_waitcnt vmcnt(8)
s_waitcnt lgkmcnt(0)
s_barrier
s_add_u32 m0, s60, 98304
s_mov_b32 s58, 1769472
buffer_load_dwordx4 v5, s[28:31], s58 offen lds
ds_read_b64_tr_b16 a[0:1], v9 offset:16384
v_cmp_eq_u32 vcc, s49, v250
v_cmp_eq_u32 s[62:63], s50, v251
s_nop 3
s_and_b64 vcc, vcc, s[62:63]
s_cmp_eq_u64 vcc, -1
s_cselect_b32 s59, 1, 0
v_cmp_ne_u32 vcc, s49, v248
s_cbranch_vccnz L_slow_17
L_bak_18:
ds_read_b64_tr_b16 a[2:3], v9 offset:20480
s_add_u32 m0, s60, 98304
s_nop 0
buffer_load_dwordx4 v6, s[28:31], s58 offen offset:1024 lds
ds_read_b64_tr_b16 a[4:5], v10 offset:16384
s_add_u32 m0, s75, 4608
s_add_u32 s52, s81, s75
buffer_load_dwordx4 v4, s[36:39], s52 offen offset:0 sc1 lds
buffer_load_dwordx4 v4, s[36:39], s52 offen offset:1024 sc1 lds
buffer_load_dwordx4 v4, s[36:39], s52 offen offset:2048 sc1 lds
buffer_load_dwordx4 v4, s[36:39], s52 offen offset:3072 sc1 lds
ds_read_b64_tr_b16 a[6:7], v10 offset:20480
s_add_u32 m0, s60, 106496
s_mov_b32 s58, 2064384
buffer_load_dwordx4 v5, s[28:31], s58 offen lds
ds_read_b64_tr_b16 a[8:9], v9 offset:24576
s_add_u32 m0, s72, 4608
s_add_u32 s52, s81, s72
buffer_load_dwordx4 v4, s[36:39], s52 offen sc1 lds
ds_read_b64_tr_b16 a[10:11], v9 offset:28672
s_add_u32 m0, s60, 106496
s_nop 0
buffer_load_dwordx4 v6, s[28:31], s58 offen offset:1024 lds
ds_read_b64_tr_b16 a[12:13], v10 offset:24576
s_mul_i32 s52, s46, 2304
s_add_u32 s52, s52, s81
s_add_u32 s52, s52, 73728
v_min_u32 v52, 2176, v241
s_cmp_lg_u32 s48, 0
s_cbranch_scc1 L_20
buffer_load_dword v252, v52, s[36:39], s52 offen sc1
L_20:
ds_read_b64_tr_b16 a[14:15], v10 offset:28672
s_waitcnt vmcnt(13)
s_waitcnt lgkmcnt(0)
s_barrier
s_add_u32 m0, s60, 114688
s_mov_b32 s58, 2359296
buffer_load_dwordx4 v5, s[28:31], s58 offen lds
ds_read_b64_tr_b16 a[16:17], v9 offset:32768
ds_read_b64_tr_b16 a[18:19], v9 offset:36864
ds_read_b64_tr_b16 a[20:21], v10 offset:32768
s_add_u32 m0, s60, 114688
s_nop 0
buffer_load_dwordx4 v6, s[28:31], s58 offen offset:1024 lds
ds_read_b64_tr_b16 a[22:23], v10 offset:36864
ds_read_b64_tr_b16 a[24:25], v9 offset:40960
ds_read_b64_tr_b16 a[26:27], v9 offset:45056
s_add_u32 m0, s60, 122880
s_mov_b32 s58, 2654208
buffer_load_dwordx4 v5, s[28:31], s58 offen lds
ds_read_b64_tr_b16 a[28:29], v10 offset:40960
ds_read_b64_tr_b16 a[30:31], v10 offset:45056
v_mfma_f32_16x16x32_bf16 v[20:23], a[0:3], v[16:19], 0
s_add_u32 m0, s60, 122880
s_nop 0
buffer_load_dwordx4 v6, s[28:31], s58 offen offset:1024 lds
v_mfma_f32_16x16x32_bf16 v[24:27], a[4:7], v[16:19], 0
v_mfma_f32_16x16x32_bf16 v[20:23], a[8:11], v[16:19], v[20:23]
v_mfma_f32_16x16x32_bf16 v[24:27], a[12:15], v[16:19], v[24:27]
s_waitcnt vmcnt(13)
s_waitcnt lgkmcnt(0)
s_barrier
s_add_u32 m0, s60, 131072
s_mov_b32 s58, 2949120
buffer_load_dwordx4 v5, s[28:31], s58 offen lds
ds_read_b64_tr_b16 a[32:33], v9 offset:49152
ds_read_b64_tr_b16 a[34:35], v9 offset:53248
ds_read_b64_tr_b16 a[36:37], v10 offset:49152
s_add_u32 m0, s60, 131072
s_nop 0
buffer_load_dwordx4 v6, s[28:31], s58 offen offset:1024 lds
ds_read_b64_tr_b16 a[38:39], v10 offset:53248
ds_read_b64_tr_b16 a[40:41], v9 offset:57344
ds_read_b64_tr_b16 a[42:43], v9 offset:61440
s_add_u32 m0, s60, 139264
s_mov_b32 s58, 3244032
buffer_load_dwordx4 v5, s[28:31], s58 offen lds
ds_read_b64_tr_b16 a[44:45], v10 offset:57344
ds_read_b64_tr_b16 a[46:47], v10 offset:61440
v_mfma_f32_16x16x32_bf16 v[20:23], a[16:19], v[16:19], v[20:23]
s_add_u32 m0, s60, 139264
s_nop 0
buffer_load_dwordx4 v6, s[28:31], s58 offen offset:1024 lds
v_mfma_f32_16x16x32_bf16 v[24:27], a[20:23], v[16:19], v[24:27]
v_mfma_f32_16x16x32_bf16 v[20:23], a[24:27], v[16:19], v[20:23]
v_mfma_f32_16x16x32_bf16 v[24:27], a[28:31], v[16:19], v[24:27]
s_waitcnt vmcnt(9)
s_waitcnt vmcnt(8)
s_waitcnt lgkmcnt(0)
s_barrier
s_add_u32 m0, s60, 147456
s_mov_b32 s58, 3538944
buffer_load_dwordx4 v5, s[28:31], s58 offen lds
ds_read_b64_tr_b16 a[48:49], v9 offset:0
ds_read_b64_tr_b16 a[144:145], v11 offset:4608
ds_read_b64_tr_b16 a[50:51], v9 offset:4096
ds_read_b64_tr_b16 a[146:147], v11 offset:5120
ds_read_b64_tr_b16 a[52:53], v10 offset:0
ds_read_b64_tr_b16 a[148:149], v11 offset:5632
s_add_u32 m0, s60, 147456
s_nop 0
buffer_load_dwordx4 v6, s[28:31], s58 offen offset:1024 lds
ds_read_b64_tr_b16 a[54:55], v10 offset:4096
ds_read_b64_tr_b16 a[150:151], v11 offset:6144
ds_read_b64_tr_b16 a[56:57], v9 offset:8192
ds_read_b64_tr_b16 a[152:153], v11 offset:6656
ds_read_b64_tr_b16 a[58:59], v9 offset:12288
ds_read_b64_tr_b16 a[154:155], v11 offset:7168
s_add_u32 m0, s60, 155648
s_mov_b32 s58, 3833856
buffer_load_dwordx4 v5, s[28:31], s58 offen lds
ds_read_b64_tr_b16 a[60:61], v10 offset:8192
ds_read_b64_tr_b16 a[156:157], v11 offset:7680
ds_read_b64_tr_b16 a[62:63], v10 offset:12288
ds_read_b64_tr_b16 a[158:159], v11 offset:8192
v_mfma_f32_16x16x32_bf16 v[20:23], a[32:35], v[16:19], v[20:23]
ds_read_b64_tr_b16 a[160:161], v11 offset:8704
s_add_u32 m0, s60, 155648
s_nop 0
buffer_load_dwordx4 v6, s[28:31], s58 offen offset:1024 lds
v_mfma_f32_16x16x32_bf16 v[24:27], a[36:39], v[16:19], v[24:27]
ds_read_b64_tr_b16 a[162:163], v11 offset:9216
v_mfma_f32_16x16x32_bf16 v[20:23], a[40:43], v[16:19], v[20:23]
ds_read_b64_tr_b16 a[164:165], v11 offset:9728
v_mfma_f32_16x16x32_bf16 v[24:27], a[44:47], v[16:19], v[24:27]
ds_read_b64_tr_b16 a[166:167], v11 offset:10240
s_waitcnt vmcnt(8)
s_waitcnt lgkmcnt(0)
s_barrier
s_add_u32 m0, s60, 98304
s_mov_b32 s58, 4128768
buffer_load_dwordx4 v5, s[28:31], s58 offen lds
ds_read_b64_tr_b16 a[64:65], v9 offset:16384
v_mfma_f32_16x16x32_bf16 v[28:31], a[144:147], v[16:19], 0
v_mfma_f32_16x16x32_bf16 v[28:31], a[148:151], v[16:19], v[28:31]
ds_read_b64_tr_b16 a[66:67], v9 offset:20480
v_mfma_f32_16x16x32_bf16 v[28:31], a[152:155], v[16:19], v[28:31]
ds_read_b64_tr_b16 a[68:69], v10 offset:16384
v_mfma_f32_16x16x32_bf16 v[28:31], a[156:159], v[16:19], v[28:31]
v_mfma_f32_16x16x32_bf16 v[28:31], a[160:163], v[16:19], v[28:31]
s_add_u32 m0, s60, 98304
s_nop 0
buffer_load_dwordx4 v6, s[28:31], s58 offen offset:1024 lds
ds_read_b64_tr_b16 a[70:71], v10 offset:20480
v_mfma_f32_16x16x32_bf16 v[28:31], a[164:167], v[16:19], v[28:31]
ds_read_b64_tr_b16 a[72:73], v9 offset:24576
ds_read_b64_tr_b16 a[168:169], v11 offset:10752
ds_read_b64_tr_b16 a[170:171], v11 offset:11264
ds_read_b64_tr_b16 a[74:75], v9 offset:28672
ds_read_b64_tr_b16 a[172:173], v11 offset:11776
s_add_u32 m0, s60, 106496
s_mov_b32 s58, 4423680
buffer_load_dwordx4 v5, s[28:31], s58 offen lds
ds_read_b64_tr_b16 a[76:77], v10 offset:24576
ds_read_b64_tr_b16 a[174:175], v11 offset:12288
ds_read_b64_tr_b16 a[176:177], v11 offset:12800
ds_read_b64_tr_b16 a[78:79], v10 offset:28672
ds_read_b64_tr_b16 a[178:179], v11 offset:13312
v_mfma_f32_16x16x32_bf16 v[20:23], a[48:51], v[16:19], v[20:23]
ds_read_b64_tr_b16 a[180:181], v11 offset:13824
ds_read_b64_tr_b16 a[182:183], v11 offset:14336
s_add_u32 m0, s60, 106496
s_nop 0
buffer_load_dwordx4 v6, s[28:31], s58 offen offset:1024 lds
v_mfma_f32_16x16x32_bf16 v[24:27], a[52:55], v[16:19], v[24:27]
ds_read_b64_tr_b16 a[184:185], v11 offset:14848
v_mfma_f32_16x16x32_bf16 v[20:23], a[56:59], v[16:19], v[20:23]
ds_read_b64_tr_b16 a[186:187], v11 offset:15360
ds_read_b64_tr_b16 a[188:189], v11 offset:15872
v_mfma_f32_16x16x32_bf16 v[24:27], a[60:63], v[16:19], v[24:27]
ds_read_b64_tr_b16 a[190:191], v11 offset:16384
s_waitcnt vmcnt(8)
s_waitcnt lgkmcnt(0)
s_barrier
s_add_u32 m0, s60, 114688
s_mov_b32 s58, 4718592
buffer_load_dwordx4 v5, s[28:31], s58 offen lds
ds_read_b64_tr_b16 a[80:81], v9 offset:32768
v_mfma_f32_16x16x32_bf16 v[28:31], a[168:171], v[16:19], v[28:31]
v_mfma_f32_16x16x32_bf16 v[28:31], a[172:175], v[16:19], v[28:31]
ds_read_b64_tr_b16 a[82:83], v9 offset:36864
v_mfma_f32_16x16x32_bf16 v[28:31], a[176:179], v[16:19], v[28:31]
ds_read_b64_tr_b16 a[84:85], v10 offset:32768
v_mfma_f32_16x16x32_bf16 v[28:31], a[180:183], v[16:19], v[28:31]
v_mfma_f32_16x16x32_bf16 v[28:31], a[184:187], v[16:19], v[28:31]
s_add_u32 m0, s60, 114688
s_nop 0
buffer_load_dwordx4 v6, s[28:31], s58 offen offset:1024 lds
ds_read_b64_tr_b16 a[86:87], v10 offset:36864
v_mfma_f32_16x16x32_bf16 v[28:31], a[188:191], v[16:19], v[28:31]
ds_read_b64_tr_b16 a[88:89], v9 offset:40960
ds_read_b64_tr_b16 a[192:193], v11 offset:16896
ds_read_b64_tr_b16 a[194:195], v11 offset:17408
ds_read_b64_tr_b16 a[90:91], v9 offset:45056
ds_read_b64_tr_b16 a[196:197], v11 offset:17920
s_add_u32 m0, s60, 122880
s_mov_b32 s58, 5013504
buffer_load_dwordx4 v5, s[28:31], s58 offen lds
ds_read_b64_tr_b16 a[92:93], v10 offset:40960
ds_read_b64_tr_b16 a[198:199], v11 offset:18432
ds_read_b64_tr_b16 a[200:201], v11 offset:18944
ds_read_b64_tr_b16 a[94:95], v10 offset:45056
ds_read_b64_tr_b16 a[202:203], v11 offset:19456
v_mfma_f32_16x16x32_bf16 v[20:23], a[64:67], v[16:19], v[20:23]
ds_read_b64_tr_b16 a[204:205], v11 offset:19968
ds_read_b64_tr_b16 a[206:207], v11 offset:20480
s_add_u32 m0, s60, 122880
s_nop 0
buffer_load_dwordx4 v6, s[28:31], s58 offen offset:1024 lds
v_mfma_f32_16x16x32_bf16 v[24:27], a[68:71], v[16:19], v[24:27]
ds_read_b64_tr_b16 a[208:209], v11 offset:20992
v_mfma_f32_16x16x32_bf16 v[20:23], a[72:75], v[16:19], v[20:23]
ds_read_b64_tr_b16 a[210:211], v11 offset:21504
ds_read_b64_tr_b16 a[212:213], v11 offset:22016
v_mfma_f32_16x16x32_bf16 v[24:27], a[76:79], v[16:19], v[24:27]
ds_read_b64_tr_b16 a[214:215], v11 offset:22528
s_waitcnt vmcnt(8)
s_waitcnt lgkmcnt(0)
s_barrier
ds_read_b64_tr_b16 a[96:97], v9 offset:49152
v_mfma_f32_16x16x32_bf16 v[28:31], a[192:195], v[16:19], v[28:31]
ds_read_b64_tr_b16 a[98:99], v9 offset:53248
ds_read_b64_tr_b16 a[100:101], v10 offset:49152
v_mfma_f32_16x16x32_bf16 v[28:31], a[196:199], v[16:19], v[28:31]
ds_read_b64_tr_b16 a[102:103], v10 offset:53248
ds_read_b64_tr_b16 a[104:105], v9 offset:57344
v_mfma_f32_16x16x32_bf16 v[28:31], a[200:203], v[16:19], v[28:31]
ds_read_b64_tr_b16 a[106:107], v9 offset:61440
ds_read_b64_tr_b16 a[108:109], v10 offset:57344
v_mfma_f32_16x16x32_bf16 v[28:31], a[204:207], v[16:19], v[28:31]
ds_read_b64_tr_b16 a[110:111], v10 offset:61440
v_mfma_f32_16x16x32_bf16 v[20:23], a[80:83], v[16:19], v[20:23]
v_mfma_f32_16x16x32_bf16 v[28:31], a[208:211], v[16:19], v[28:31]
v_mfma_f32_16x16x32_bf16 v[24:27], a[84:87], v[16:19], v[24:27]
v_mfma_f32_16x16x32_bf16 v[20:23], a[88:91], v[16:19], v[20:23]
v_mfma_f32_16x16x32_bf16 v[28:31], a[212:215], v[16:19], v[28:31]
v_mfma_f32_16x16x32_bf16 v[24:27], a[92:95], v[16:19], v[24:27]
s_waitcnt vmcnt(4)
s_waitcnt lgkmcnt(0)
s_barrier
ds_read_b64_tr_b16 a[112:113], v9 offset:0
ds_read_b64_tr_b16 a[114:115], v9 offset:4096
ds_read_b64_tr_b16 a[116:117], v10 offset:0
ds_read_b64_tr_b16 a[118:119], v10 offset:4096
ds_read_b64_tr_b16 a[120:121], v9 offset:8192
ds_read_b64_tr_b16 a[122:123], v9 offset:12288
ds_read_b64_tr_b16 a[124:125], v10 offset:8192
ds_read_b64_tr_b16 a[126:127], v10 offset:12288
v_mfma_f32_16x16x32_bf16 v[20:23], a[96:99], v[16:19], v[20:23]
v_mfma_f32_16x16x32_bf16 v[24:27], a[100:103], v[16:19], v[24:27]
v_mfma_f32_16x16x32_bf16 v[20:23], a[104:107], v[16:19], v[20:23]
v_mfma_f32_16x16x32_bf16 v[24:27], a[108:111], v[16:19], v[24:27]
s_waitcnt vmcnt(0)
s_waitcnt lgkmcnt(0)
s_barrier
ds_read_b64_tr_b16 a[128:129], v9 offset:16384
buffer_load_dword v249, v238, s[36:39], 0 offen sc1
ds_read_b64_tr_b16 a[130:131], v9 offset:20480
ds_read_b64_tr_b16 a[132:133], v10 offset:16384
ds_read_b64_tr_b16 a[134:135], v10 offset:20480
ds_read_b64_tr_b16 a[136:137], v9 offset:24576
ds_read_b64_tr_b16 a[138:139], v9 offset:28672
ds_read_b64_tr_b16 a[140:141], v10 offset:24576
ds_read_b64_tr_b16 a[142:143], v10 offset:28672
v_mfma_f32_16x16x32_bf16 v[20:23], a[112:115], v[16:19], v[20:23]
v_mfma_f32_16x16x32_bf16 v[24:27], a[116:119], v[16:19], v[24:27]
v_mfma_f32_16x16x32_bf16 v[20:23], a[120:123], v[16:19], v[20:23]
v_mfma_f32_16x16x32_bf16 v[24:27], a[124:127], v[16:19], v[24:27]
s_waitcnt lgkmcnt(0)
v_mfma_f32_16x16x32_bf16 v[20:23], a[128:131], v[16:19], v[20:23]
v_mfma_f32_16x16x32_bf16 v[24:27], a[132:135], v[16:19], v[24:27]
v_mfma_f32_16x16x32_bf16 v[20:23], a[136:139], v[16:19], v[20:23]
v_mfma_f32_16x16x32_bf16 v[24:27], a[140:143], v[16:19], v[24:27]
s_branch L_main
L_helper:
s_mov_b32 s24, s8
s_and_b32 s25, s9, 0xffff
s_mov_b32 s26, 663552
s_mov_b32 s27, 0x20000
s_cmp_ge_u32 s45, 28
s_cbranch_scc1 L_23
s_add_u32 s52, s45, 3
s_lshl_b32 s52, s52, 13
s_waitcnt vmcnt(2)
buffer_load_dword v60, v59, s[24:27], s52 offen
s_add_u32 s52, s52, 81920
s_waitcnt vmcnt(2)
buffer_load_dword v60, v59, s[24:27], s52 offen
s_add_u32 s52, s52, 81920
s_waitcnt vmcnt(2)
buffer_load_dword v60, v59, s[24:27], s52 offen
s_add_u32 s52, s52, 81920
s_waitcnt vmcnt(2)
buffer_load_dword v60, v59, s[24:27], s52 offen
s_add_u32 s52, s52, 81920
s_waitcnt vmcnt(2)
buffer_load_dword v60, v59, s[24:27], s52 offen
s_add_u32 s52, s52, 81920
s_waitcnt vmcnt(2)
buffer_load_dword v60, v59, s[24:27], s52 offen
s_add_u32 s52, s52, 81920
L_23:
s_mov_b32 s36, s18
s_and_b32 s37, s19, 0xffff
s_mov_b32 s38, 16777216
s_mov_b32 s39, 0x20000
s_getreg_b32 s50, hwreg(HW_REG_XCC_ID)
v_and_b32 v2, 15, v0
v_bfe_u32 v3, v0, 4, 2
v_lshlrev_b32 v4, 4, v1
s_mov_b32 s64, 0xc0135761
s_mov_b32 s65, 0xbdd2d3e8
s_mov_b32 s28, s10
s_and_b32 s29, s11, 0xffff
s_mov_b32 s30, 5308416
s_mov_b32 s31, 0x20000
s_mov_b32 s32, s12
s_and_b32 s33, s13, 0xffff
s_mov_b32 s34, 5308416
s_mov_b32 s35, 0x20000
s_mov_b32 s40, s14
s_and_b32 s41, s15, 0xffff
s_mov_b32 s42, 589824
s_mov_b32 s43, 0x20000
s_lshr_b32 s46, s45, 2
s_and_b32 s47, s45, 3
v_lshlrev_b32 v13, 3, v1
s_lshl_b32 s60, s48, 11
s_lshl_b32 s52, s48, 3
v_add_u32 v56, s52, v3
v_lshrrev_b32 v57, 1, v2
v_xor_b32 v57, v57, v3
v_and_b32 v58, 1, v2
v_lshlrev_b32 v58, 4, v58
v_lshl_add_u32 v57, v57, 5, v58
v_xor_b32 v58, 128, v57
s_mul_i32 s53, s44, 1152
s_lshl_b32 s54, s47, 8
s_add_u32 s53, s53, s54
v_mul_u32_u24 v5, 9216, v56
v_add_u32 v5, s53, v5
v_add_u32 v6, 35840, v5
v_add_u32 v5, v5, v57
v_add_u32 v6, v6, v58
s_mul_i32 s53, s44, 663552
s_add_u32 s53, s53, s54
v_mul_u32_u24 v7, 1152, v56
v_add_u32 v7, s53, v7
v_add_u32 v8, 3584, v7
v_add_u32 v7, v7, v57
v_add_u32 v8, v8, v58
v_mov_b32 v158, 163840
s_cmp_ge_u32 s45, 28
s_cbranch_scc1 L_22
v_lshrrev_b32 v56, 3, v1
v_and_b32 v57, 7, v1
v_lshlrev_b32 v57, 7, v57
v_mul_u32_u24 v225, 9216, v56
v_add_u32 v225, v225, v57
v_mul_u32_u24 v254, 1152, v56
v_add_u32 v254, v254, v57
s_sub_u32 s51, s45, 18
s_lshl_b32 s51, s51, 2
s_add_u32 s51, s51, s48
s_waitcnt lgkmcnt(0)
s_add_u32 s49, s49, 1
v_mov_b32 v14, s49
s_lshl_b32 s52, s2, 7
s_add_u32 s52, s52, 4096
v_mov_b32 v52, s52
v_mov_b32 v54, s49
v_mov_b32 v55, s50
s_cmp_lg_u32 s48, 0
s_cbranch_scc1 L_24
buffer_store_dwordx2 v[54:55], v52, s[36:39], 0 offen sc1
L_24:
s_sub_u32 s54, s51, 0
s_mul_i32 s52, s54, 73728
s_mul_i32 s53, s44, 1152
s_add_u32 s52, s52, s53
s_add_u32 s52, s52, 0
s_cmp_ge_u32 s54, 40
s_cbranch_scc1 L_25
buffer_load_dword v60, v225, s[28:31], s52 offen
L_25:
v_lshrrev_b32 v56, 2, v1
v_and_b32 v57, 3, v1
v_lshlrev_b32 v57, 3, v57
v_lshl_add_u32 v11, v56, 5, v57
v_add_u32 v15, 98304, v11
v_and_b32 v58, 7, v56
s_lshl_b32 s52, s48, 1
v_xor_b32 v58, s52, v58
v_lshl_add_u32 v58, v58, 5, v57
v_lshl_add_u32 v58, v56, 8, v58
v_add_u32 v9, 98304, v58
v_xor_b32 v58, 32, v58
v_add_u32 v10, 98304, v58
v_subrev_u32 v242, 16384, v9
v_subrev_u32 v243, 16384, v10
v_add_u32 v224, 4608, v4
v_add_u32 v12, 41472, v4
v_mov_b32 v16, 0x3f803f80
v_mov_b32 v17, 0x3f803f80
v_mov_b32 v18, 0x3f803f80
v_mov_b32 v19, 0x3f803f80
s_lshl_b32 s75, s48, 12
s_mul_i32 s52, s48, 18432
v_add_u32 v232, s52, v224
s_add_u32 s71, s52, 16384
s_mul_i32 s78, s46, 81920
s_add_u32 s78, s78, 2097152
s_lshl_b32 s55, s44, 3
s_add_u32 s56, s55, s47
s_mul_i32 s81, s56, 18432
s_add_u32 s81, s81, 3145728
s_lshl_b32 s72, s48, 9
s_add_u32 s72, s72, 16384
s_add_u32 s55, s55, s46
s_mul_i32 s79, s55, 73728
s_add_u32 s79, s79, 5242880
s_lshr_b32 s53, s47, 1
s_lshl_b32 s53, s53, 10
s_add_u32 s53, s53, s71
s_add_u32 s53, s53, s79
s_and_b32 s54, s47, 1
s_lshl_b32 s54, s54, 3
s_add_u32 s54, s54, s53
v_add_u32 v229, s54, v4
s_lshl_b32 s52, s47, 2
s_add_u32 s52, s52, s48
s_lshl_b32 s54, s52, 10
s_add_u32 s54, s54, s79
v_add_u32 v228, s54, v4
s_lshl_b32 s55, s55, 10
s_add_u32 s55, s55, 196608
v_lshlrev_b32 v56, 2, v2
v_add_u32 v231, s55, v56
s_lshl_b32 s52, s52, 2
s_add_u32 s52, s52, s55
v_mov_b32 v230, s52
v_and_b32 v56, 3, v1
s_lshl_b32 s52, s44, 9
s_add_u32 s52, s52, 163840
v_lshlrev_b32 v57, 7, v56
v_add_u32 v239, s52, v57
s_lshl_b32 s52, s46, 5
s_add_u32 s52, s52, s44
s_lshl_b32 s52, s52, 7
s_add_u32 s52, s52, 4096
v_lshlrev_b32 v57, 10, v56
v_add_u32 v240, s52, v57
s_mul_i32 s52, s46, 1152
s_add_u32 s52, s52, 73728
v_min_u32 v57, 8, v1
v_lshlrev_b32 v57, 7, v57
v_add_u32 v238, s52, v57
s_and_b32 s53, s44, 1
s_lshl_b32 s53, s53, 1
s_add_u32 s53, s53, s48
s_lshl_b32 s54, s47, 2
s_add_u32 s53, s53, s54
s_lshr_b32 s54, s47, 1
s_add_u32 s54, s54, 16
s_cmp_ge_u32 s48, 2
s_cselect_b32 s53, s54, s53
s_lshl_b32 s53, s53, 10
s_lshr_b32 s52, s44, 1
s_mul_i32 s52, s52, 18432
s_add_u32 s52, s52, s53
v_add_u32 v233, s52, v224
s_mul_i32 s80, s45, 147456
s_add_u32 s80, s80, 10485760
s_mul_i32 s52, s44, 4608
s_add_u32 s52, s52, s80
s_add_u32 s53, s70, s52
v_add_u32 v234, s53, v4
s_mul_i32 s53, s48, 36864
s_add_u32 s53, s53, s52
s_add_u32 s53, s53, 4096
v_add_u32 v235, s53, v13
s_lshl_b32 s52, s45, 10
s_add_u32 s52, s52, 131072
v_and_b32 v56, 7, v1
v_lshlrev_b32 v56, 7, v56
v_lshl_add_u32 v56, v3, 2, v56
v_add_u32 v237, s52, v56
s_lshl_b32 s53, s44, 5
s_add_u32 s53, s53, s48
s_lshl_b32 s53, s53, 2
s_add_u32 s52, s52, s53
v_mov_b32 v236, s52
v_mul_u32_u24 v253, 1152, v2
v_lshl_add_u32 v253, v3, 3, v253
v_mov_b32 v52, -1
v_mov_b32 v53, -1
v_mov_b32 v54, -1
v_mov_b32 v55, -1
s_mov_b32 s52, 0
buffer_store_dwordx4 v[52:55], v234, s[36:39], s52 offen sc1
s_mov_b32 s52, 36864
buffer_store_dwordx4 v[52:55], v234, s[36:39], s52 offen sc1
s_mov_b32 s52, 73728
buffer_store_dwordx4 v[52:55], v234, s[36:39], s52 offen sc1
s_mov_b32 s52, 110592
buffer_store_dwordx4 v[52:55], v234, s[36:39], s52 offen sc1
buffer_store_dwordx2 v[52:53], v235, s[36:39], 0 offen sc1
s_nop 0
s_sub_u32 s54, s51, 0
s_mul_i32 s52, s54, 73728
s_mul_i32 s53, s44, 1152
s_add_u32 s52, s52, s53
s_add_u32 s52, s52, 2949120
s_cmp_ge_u32 s54, 32
s_cbranch_scc1 L_26
buffer_load_dword v60, v225, s[28:31], s52 offen
L_26:
s_sub_u32 s54, s51, 32
s_mul_i32 s52, s54, 9216
s_mul_i32 s53, s44, 663552
s_add_u32 s52, s52, s53
s_add_u32 s52, s52, 479232
s_cmp_ge_u32 s54, 8
s_cbranch_scc1 L_27
buffer_load_dword v60, v254, s[32:35], s52 offen
L_27:
s_lshl_b32 s52, s44, 13
s_add_u32 s52, s52, 196608
s_cmp_lg_u32 s51, 39
s_cbranch_scc1 L_21
buffer_load_dword v60, v241, s[36:39], s52 offen
s_branch L_21
L_22:
v_lshrrev_b32 v56, 3, v1
v_and_b32 v57, 7, v1
v_lshlrev_b32 v57, 7, v57
v_mul_u32_u24 v225, 9216, v56
v_add_u32 v225, v225, v57
v_mul_u32_u24 v254, 1152, v56
v_add_u32 v254, v254, v57
s_sub_u32 s51, s45, 28
s_lshl_b32 s51, s51, 2
s_add_u32 s51, s51, s48
s_waitcnt lgkmcnt(0)
s_add_u32 s49, s49, 1
v_mov_b32 v14, s49
s_lshl_b32 s52, s2, 7
s_add_u32 s52, s52, 4096
v_mov_b32 v52, s52
v_mov_b32 v54, s49
v_mov_b32 v55, s50
s_cmp_lg_u32 s48, 0
s_cbranch_scc1 L_28
buffer_store_dwordx2 v[54:55], v52, s[36:39], 0 offen sc1
L_28:
s_sub_u32 s66, s45, 28
s_lshr_b32 s67, s66, 1
s_and_b32 s68, s66, 1
s_mul_i32 s68, s68, 288
v_lshrrev_b32 v56, 3, v0
v_add_u32 v56, s68, v56
v_and_b32 v57, 7, v1
s_cmp_eq_u32 s67, 0
s_movk_i32 s53, 1152
s_cselect_b32 s69, 9216, s53
s_cselect_b32 s52, s53, 663552
s_cselect_b32 s24, s10, s12
s_cselect_b32 s25, s11, s13
s_and_b32 s25, s25, 0xffff
s_mov_b32 s26, 5308416
s_mov_b32 s27, 0x20000
s_mul_i32 s52, s52, s44
s_add_u32 s52, s52, 1024
v_mul_lo_u32 v156, v56, s69
v_lshlrev_b32 v58, 4, v57
v_add3_u32 v156, v156, v58, s52
s_lshl_b32 s69, s69, 5
s_mov_b32 s53, 0
buffer_load_dwordx4 v[80:83], v156, s[24:27], s53 offen
s_add_u32 s53, s53, s69
buffer_load_dwordx4 v[84:87], v156, s[24:27], s53 offen
s_add_u32 s53, s53, s69
buffer_load_dwordx4 v[88:91], v156, s[24:27], s53 offen
s_add_u32 s53, s53, s69
buffer_load_dwordx4 v[92:95], v156, s[24:27], s53 offen
s_add_u32 s53, s53, s69
buffer_load_dwordx4 v[96:99], v156, s[24:27], s53 offen
s_add_u32 s53, s53, s69
buffer_load_dwordx4 v[100:103], v156, s[24:27], s53 offen
s_add_u32 s53, s53, s69
buffer_load_dwordx4 v[104:107], v156, s[24:27], s53 offen
s_add_u32 s53, s53, s69
buffer_load_dwordx4 v[108:111], v156, s[24:27], s53 offen
s_add_u32 s53, s53, s69
buffer_load_dwordx4 v[112:115], v156, s[24:27], s53 offen
s_add_u32 s53, s53, s69
s_lshl_b32 s52, s44, 1
s_add_u32 s52, s52, s67
s_mul_i32 s52, s52, 73728
s_add_u32 s52, s52, 3145728
v_lshrrev_b32 v58, 1, v57
v_mul_u32_u24 v58, 18432, v58
v_lshl_add_u32 v58, v56, 5, v58
v_and_b32 v57, 1, v57
v_lshlrev_b32 v57, 4, v57
v_add3_u32 v157, v58, v57, s52
s_lshl_b32 s52, s44, 2
s_add_u32 s52, s52, s66
s_lshl_b32 s52, s52, 7
s_add_u32 s52, s52, 163840
v_mov_b32 v158, s52
v_lshrrev_b32 v56, 2, v1
v_and_b32 v57, 3, v1
v_lshlrev_b32 v57, 3, v57
v_lshl_add_u32 v11, v56, 5, v57
v_add_u32 v15, 98304, v11
v_and_b32 v58, 7, v56
s_lshl_b32 s52, s48, 1
v_xor_b32 v58, s52, v58
v_lshl_add_u32 v58, v58, 5, v57
v_lshl_add_u32 v58, v56, 8, v58
v_add_u32 v9, 98304, v58
v_xor_b32 v58, 32, v58
v_add_u32 v10, 98304, v58
v_subrev_u32 v242, 16384, v9
v_subrev_u32 v243, 16384, v10
v_add_u32 v224, 4608, v4
v_add_u32 v12, 41472, v4
v_mov_b32 v16, 0x3f803f80
v_mov_b32 v17, 0x3f803f80
v_mov_b32 v18, 0x3f803f80
v_mov_b32 v19, 0x3f803f80
s_lshl_b32 s75, s48, 12
s_mul_i32 s52, s48, 18432
v_add_u32 v232, s52, v224
s_add_u32 s71, s52, 16384
s_mul_i32 s78, s46, 81920
s_add_u32 s78, s78, 2097152
s_lshl_b32 s55, s44, 3
s_add_u32 s56, s55, s47
s_mul_i32 s81, s56, 18432
s_add_u32 s81, s81, 3145728
s_lshl_b32 s72, s48, 9
s_add_u32 s72, s72, 16384
s_add_u32 s55, s55, s46
s_mul_i32 s79, s55, 73728
s_add_u32 s79, s79, 5242880
s_lshr_b32 s53, s47, 1
s_lshl_b32 s53, s53, 10
s_add_u32 s53, s53, s71
s_add_u32 s53, s53, s79
s_and_b32 s54, s47, 1
s_lshl_b32 s54, s54, 3
s_add_u32 s54, s54, s53
v_add_u32 v229, s54, v4
s_lshl_b32 s52, s47, 2
s_add_u32 s52, s52, s48
s_lshl_b32 s54, s52, 10
s_add_u32 s54, s54, s79
v_add_u32 v228, s54, v4
s_lshl_b32 s55, s55, 10
s_add_u32 s55, s55, 196608
v_lshlrev_b32 v56, 2, v2
v_add_u32 v231, s55, v56
s_lshl_b32 s52, s52, 2
s_add_u32 s52, s52, s55
v_mov_b32 v230, s52
v_and_b32 v56, 3, v1
s_lshl_b32 s52, s44, 9
s_add_u32 s52, s52, 163840
v_lshlrev_b32 v57, 7, v56
v_add_u32 v239, s52, v57
s_lshl_b32 s52, s46, 5
s_add_u32 s52, s52, s44
s_lshl_b32 s52, s52, 7
s_add_u32 s52, s52, 4096
v_lshlrev_b32 v57, 10, v56
v_add_u32 v240, s52, v57
s_mul_i32 s52, s46, 1152
s_add_u32 s52, s52, 73728
v_min_u32 v57, 8, v1
v_lshlrev_b32 v57, 7, v57
v_add_u32 v238, s52, v57
s_and_b32 s53, s44, 1
s_lshl_b32 s53, s53, 1
s_add_u32 s53, s53, s48
s_lshl_b32 s54, s47, 2
s_add_u32 s53, s53, s54
s_lshr_b32 s54, s47, 1
s_add_u32 s54, s54, 16
s_cmp_ge_u32 s48, 2
s_cselect_b32 s53, s54, s53
s_lshl_b32 s53, s53, 10
s_lshr_b32 s52, s44, 1
s_mul_i32 s52, s52, 18432
s_add_u32 s52, s52, s53
v_add_u32 v233, s52, v224
s_mul_i32 s80, s45, 147456
s_add_u32 s80, s80, 10485760
s_mul_i32 s52, s44, 4608
s_add_u32 s52, s52, s80
s_add_u32 s53, s70, s52
v_add_u32 v234, s53, v4
s_mul_i32 s53, s48, 36864
s_add_u32 s53, s53, s52
s_add_u32 s53, s53, 4096
v_add_u32 v235, s53, v13
s_lshl_b32 s52, s45, 10
s_add_u32 s52, s52, 131072
v_and_b32 v56, 7, v1
v_lshlrev_b32 v56, 7, v56
v_lshl_add_u32 v56, v3, 2, v56
v_add_u32 v237, s52, v56
s_lshl_b32 s53, s44, 5
s_add_u32 s53, s53, s48
s_lshl_b32 s53, s53, 2
s_add_u32 s52, s52, s53
v_mov_b32 v236, s52
v_mul_u32_u24 v253, 1152, v2
v_lshl_add_u32 v253, v3, 3, v253
s_mov_b32 s53, 0
s_waitcnt vmcnt(8)
buffer_store_dwordx4 v[80:83], v157, s[36:39], s53 offen sc1
s_add_u32 s53, s53, 1024
s_waitcnt vmcnt(8)
buffer_store_dwordx4 v[84:87], v157, s[36:39], s53 offen sc1
s_add_u32 s53, s53, 1024
s_waitcnt vmcnt(8)
buffer_store_dwordx4 v[88:91], v157, s[36:39], s53 offen sc1
s_add_u32 s53, s53, 1024
s_waitcnt vmcnt(8)
buffer_store_dwordx4 v[92:95], v157, s[36:39], s53 offen sc1
s_add_u32 s53, s53, 1024
s_waitcnt vmcnt(8)
buffer_store_dwordx4 v[96:99], v157, s[36:39], s53 offen sc1
s_add_u32 s53, s53, 1024
s_waitcnt vmcnt(8)
buffer_store_dwordx4 v[100:103], v157, s[36:39], s53 offen sc1
s_add_u32 s53, s53, 1024
s_waitcnt vmcnt(8)
buffer_store_dwordx4 v[104:107], v157, s[36:39], s53 offen sc1
s_add_u32 s53, s53, 1024
s_waitcnt vmcnt(8)
buffer_store_dwordx4 v[108:111], v157, s[36:39], s53 offen sc1
s_add_u32 s53, s53, 1024
s_waitcnt vmcnt(8)
buffer_store_dwordx4 v[112:115], v157, s[36:39], s53 offen sc1
s_add_u32 s53, s53, 1024
s_waitcnt vmcnt(0)
s_barrier
s_cmp_lg_u32 s48, 0
s_cbranch_scc1 L_29
buffer_store_dword v14, v158, s[36:39], 0 offen sc1
L_29:
v_mov_b32 v52, -1
v_mov_b32 v53, -1
v_mov_b32 v54, -1
v_mov_b32 v55, -1
s_mov_b32 s52, 0
buffer_store_dwordx4 v[52:55], v234, s[36:39], s52 offen sc1
s_mov_b32 s52, 36864
buffer_store_dwordx4 v[52:55], v234, s[36:39], s52 offen sc1
s_mov_b32 s52, 73728
buffer_store_dwordx4 v[52:55], v234, s[36:39], s52 offen sc1
s_mov_b32 s52, 110592
buffer_store_dwordx4 v[52:55], v234, s[36:39], s52 offen sc1
buffer_store_dwordx2 v[52:53], v235, s[36:39], 0 offen sc1
s_nop 0
s_sub_u32 s54, s51, 0
s_mul_i32 s52, s54, 9216
s_mul_i32 s53, s44, 663552
s_add_u32 s52, s52, s53
s_add_u32 s52, s52, 331776
s_cmp_ge_u32 s54, 16
s_cbranch_scc1 L_30
buffer_load_dword v60, v254, s[32:35], s52 offen
L_30:
s_add_u32 s51, s51, 40
L_21:
s_add_u32 m0, s60, 114688
s_mov_b32 s58, 0
buffer_load_dwordx4 v5, s[28:31], s58 offen lds
s_add_u32 m0, s60, 114688
s_nop 0
buffer_load_dwordx4 v6, s[28:31], s58 offen offset:1024 lds
s_add_u32 m0, s60, 122880
s_mov_b32 s58, 294912
buffer_load_dwordx4 v5, s[28:31], s58 offen lds
s_add_u32 m0, s60, 122880
s_nop 0
buffer_load_dwordx4 v6, s[28:31], s58 offen offset:1024 lds
s_add_u32 m0, s60, 131072
s_mov_b32 s58, 589824
buffer_load_dwordx4 v5, s[28:31], s58 offen lds
s_add_u32 m0, s60, 131072
s_nop 0
buffer_load_dwordx4 v6, s[28:31], s58 offen offset:1024 lds
s_add_u32 m0, s60, 139264
s_mov_b32 s58, 884736
buffer_load_dwordx4 v5, s[28:31], s58 offen lds
s_add_u32 m0, s60, 139264
s_nop 0
buffer_load_dwordx4 v6, s[28:31], s58 offen offset:1024 lds
s_add_u32 m0, s60, 147456
s_mov_b32 s58, 1179648
buffer_load_dwordx4 v5, s[28:31], s58 offen lds
s_add_u32 m0, s60, 147456
s_nop 0
buffer_load_dwordx4 v6, s[28:31], s58 offen offset:1024 lds
s_add_u32 m0, s60, 155648
s_mov_b32 s58, 1474560
buffer_load_dwordx4 v5, s[28:31], s58 offen lds
s_add_u32 m0, s60, 155648
s_nop 0
buffer_load_dwordx4 v6, s[28:31], s58 offen offset:1024 lds
s_waitcnt vmcnt(8)
s_waitcnt lgkmcnt(0)
s_barrier
s_add_u32 m0, s60, 98304
s_mov_b32 s58, 1769472
buffer_load_dwordx4 v5, s[28:31], s58 offen lds
ds_read_b64_tr_b16 a[0:1], v9 offset:16384
buffer_load_dword v248, v239, s[36:39], 0 offen sc1
ds_read_b64_tr_b16 a[2:3], v9 offset:20480
s_add_u32 m0, s60, 98304
s_nop 0
buffer_load_dwordx4 v6, s[28:31], s58 offen offset:1024 lds
ds_read_b64_tr_b16 a[4:5], v10 offset:16384
ds_read_b64_tr_b16 a[6:7], v10 offset:20480
s_add_u32 m0, s60, 106496
s_mov_b32 s58, 2064384
buffer_load_dwordx4 v5, s[28:31], s58 offen lds
ds_read_b64_tr_b16 a[8:9], v9 offset:24576
buffer_load_dwordx2 v[250:251], v240, s[36:39], 0 offen sc1
ds_read_b64_tr_b16 a[10:11], v9 offset:28672
s_add_u32 m0, s60, 106496
s_nop 0
buffer_load_dwordx4 v6, s[28:31], s58 offen offset:1024 lds
ds_read_b64_tr_b16 a[12:13], v10 offset:24576
ds_read_b64_tr_b16 a[14:15], v10 offset:28672
s_waitcnt vmcnt(10)
s_waitcnt lgkmcnt(0)
s_barrier
s_add_u32 m0, s60, 114688
s_mov_b32 s58, 2359296
buffer_load_dwordx4 v5, s[28:31], s58 offen lds
ds_read_b64_tr_b16 a[16:17], v9 offset:32768
ds_read_b64_tr_b16 a[18:19], v9 offset:36864
ds_read_b64_tr_b16 a[20:21], v10 offset:32768
s_add_u32 m0, s60, 114688
s_nop 0
buffer_load_dwordx4 v6, s[28:31], s58 offen offset:1024 lds
ds_read_b64_tr_b16 a[22:23], v10 offset:36864
ds_read_b64_tr_b16 a[24:25], v9 offset:40960
ds_read_b64_tr_b16 a[26:27], v9 offset:45056
s_add_u32 m0, s60, 122880
s_mov_b32 s58, 2654208
buffer_load_dwordx4 v5, s[28:31], s58 offen lds
ds_read_b64_tr_b16 a[28:29], v10 offset:40960
ds_read_b64_tr_b16 a[30:31], v10 offset:45056
v_mfma_f32_16x16x32_bf16 v[20:23], a[0:3], v[16:19], 0
s_add_u32 m0, s60, 122880
s_nop 0
buffer_load_dwordx4 v6, s[28:31], s58 offen offset:1024 lds
v_mfma_f32_16x16x32_bf16 v[24:27], a[4:7], v[16:19], 0
v_mfma_f32_16x16x32_bf16 v[20:23], a[8:11], v[16:19], v[20:23]
v_mfma_f32_16x16x32_bf16 v[24:27], a[12:15], v[16:19], v[24:27]
s_waitcnt vmcnt(10)
s_waitcnt lgkmcnt(0)
s_barrier
s_add_u32 m0, s60, 131072
s_mov_b32 s58, 2949120
buffer_load_dwordx4 v5, s[28:31], s58 offen lds
ds_read_b64_tr_b16 a[32:33], v9 offset:49152
s_waitcnt vmcnt(6)
v_cmp_eq_u32 vcc, s49, v250
v_cmp_eq_u32 s[62:63], s50, v251
s_nop 3
s_and_b64 vcc, vcc, s[62:63]
s_cmp_eq_u64 vcc, -1
s_cselect_b32 s59, 1, 0
v_cmp_ne_u32 vcc, s49, v248
s_cbranch_vccnz L_slow_31
L_bak_32:
ds_read_b64_tr_b16 a[34:35], v9 offset:53248
ds_read_b64_tr_b16 a[36:37], v10 offset:49152
s_add_u32 m0, s60, 131072
s_nop 0
buffer_load_dwordx4 v6, s[28:31], s58 offen offset:1024 lds
ds_read_b64_tr_b16 a[38:39], v10 offset:53248
s_add_u32 m0, s75, 4608
s_add_u32 s52, s81, s75
buffer_load_dwordx4 v4, s[36:39], s52 offen offset:0 sc1 lds
buffer_load_dwordx4 v4, s[36:39], s52 offen offset:1024 sc1 lds
buffer_load_dwordx4 v4, s[36:39], s52 offen offset:2048 sc1 lds
buffer_load_dwordx4 v4, s[36:39], s52 offen offset:3072 sc1 lds
ds_read_b64_tr_b16 a[40:41], v9 offset:57344
ds_read_b64_tr_b16 a[42:43], v9 offset:61440
s_add_u32 m0, s60, 139264
s_mov_b32 s58, 3244032
buffer_load_dwordx4 v5, s[28:31], s58 offen lds
ds_read_b64_tr_b16 a[44:45], v10 offset:57344
s_add_u32 m0, s72, 4608
s_add_u32 s52, s81, s72
buffer_load_dwordx4 v4, s[36:39], s52 offen sc1 lds
ds_read_b64_tr_b16 a[46:47], v10 offset:61440
v_mfma_f32_16x16x32_bf16 v[20:23], a[16:19], v[16:19], v[20:23]
s_add_u32 m0, s60, 139264
s_nop 0
buffer_load_dwordx4 v6, s[28:31], s58 offen offset:1024 lds
v_mfma_f32_16x16x32_bf16 v[24:27], a[20:23], v[16:19], v[24:27]
s_mul_i32 s52, s46, 2304
s_add_u32 s52, s52, s81
s_add_u32 s52, s52, 73728
v_min_u32 v52, 2176, v241
s_cmp_lg_u32 s48, 0
s_cbranch_scc1 L_34
buffer_load_dword v252, v52, s[36:39], s52 offen sc1
L_34:
v_mfma_f32_16x16x32_bf16 v[20:23], a[24:27], v[16:19], v[20:23]
v_mfma_f32_16x16x32_bf16 v[24:27], a[28:31], v[16:19], v[24:27]
s_waitcnt vmcnt(13)
s_waitcnt lgkmcnt(0)
s_barrier
s_add_u32 m0, s60, 147456
s_mov_b32 s58, 3538944
buffer_load_dwordx4 v5, s[28:31], s58 offen lds
ds_read_b64_tr_b16 a[48:49], v9 offset:0
ds_read_b64_tr_b16 a[50:51], v9 offset:4096
ds_read_b64_tr_b16 a[52:53], v10 offset:0
s_add_u32 m0, s60, 147456
s_nop 0
buffer_load_dwordx4 v6, s[28:31], s58 offen offset:1024 lds
ds_read_b64_tr_b16 a[54:55], v10 offset:4096
ds_read_b64_tr_b16 a[56:57], v9 offset:8192
ds_read_b64_tr_b16 a[58:59], v9 offset:12288
s_add_u32 m0, s60, 155648
s_mov_b32 s58, 3833856
buffer_load_dwordx4 v5, s[28:31], s58 offen lds
ds_read_b64_tr_b16 a[60:61], v10 offset:8192
ds_read_b64_tr_b16 a[62:63], v10 offset:12288
v_mfma_f32_16x16x32_bf16 v[20:23], a[32:35], v[16:19], v[20:23]
s_add_u32 m0, s60, 155648
s_nop 0
buffer_load_dwordx4 v6, s[28:31], s58 offen offset:1024 lds
v_mfma_f32_16x16x32_bf16 v[24:27], a[36:39], v[16:19], v[24:27]
v_mfma_f32_16x16x32_bf16 v[20:23], a[40:43], v[16:19], v[20:23]
v_mfma_f32_16x16x32_bf16 v[24:27], a[44:47], v[16:19], v[24:27]
s_waitcnt vmcnt(13)
s_waitcnt lgkmcnt(0)
s_barrier
s_add_u32 m0, s60, 98304
s_mov_b32 s58, 4128768
buffer_load_dwordx4 v5, s[28:31], s58 offen lds
ds_read_b64_tr_b16 a[64:65], v9 offset:16384
ds_read_b64_tr_b16 a[66:67], v9 offset:20480
ds_read_b64_tr_b16 a[68:69], v10 offset:16384
s_add_u32 m0, s60, 98304
s_nop 0
buffer_load_dwordx4 v6, s[28:31], s58 offen offset:1024 lds
ds_read_b64_tr_b16 a[70:71], v10 offset:20480
ds_read_b64_tr_b16 a[72:73], v9 offset:24576
ds_read_b64_tr_b16 a[74:75], v9 offset:28672
s_add_u32 m0, s60, 106496
s_mov_b32 s58, 4423680
buffer_load_dwordx4 v5, s[28:31], s58 offen lds
ds_read_b64_tr_b16 a[76:77], v10 offset:24576
ds_read_b64_tr_b16 a[78:79], v10 offset:28672
v_mfma_f32_16x16x32_bf16 v[20:23], a[48:51], v[16:19], v[20:23]
s_add_u32 m0, s60, 106496
s_nop 0
buffer_load_dwordx4 v6, s[28:31], s58 offen offset:1024 lds
v_mfma_f32_16x16x32_bf16 v[24:27], a[52:55], v[16:19], v[24:27]
v_mfma_f32_16x16x32_bf16 v[20:23], a[56:59], v[16:19], v[20:23]
v_mfma_f32_16x16x32_bf16 v[24:27], a[60:63], v[16:19], v[24:27]
s_waitcnt vmcnt(9)
s_waitcnt vmcnt(8)
s_waitcnt lgkmcnt(0)
s_barrier
s_add_u32 m0, s60, 114688
s_mov_b32 s58, 4718592
buffer_load_dwordx4 v5, s[28:31], s58 offen lds
ds_read_b64_tr_b16 a[80:81], v9 offset:32768
ds_read_b64_tr_b16 a[144:145], v11 offset:4608
ds_read_b64_tr_b16 a[82:83], v9 offset:36864
ds_read_b64_tr_b16 a[146:147], v11 offset:5120
ds_read_b64_tr_b16 a[84:85], v10 offset:32768
ds_read_b64_tr_b16 a[148:149], v11 offset:5632
s_add_u32 m0, s60, 114688
s_nop 0
buffer_load_dwordx4 v6, s[28:31], s58 offen offset:1024 lds
ds_read_b64_tr_b16 a[86:87], v10 offset:36864
ds_read_b64_tr_b16 a[150:151], v11 offset:6144
ds_read_b64_tr_b16 a[88:89], v9 offset:40960
ds_read_b64_tr_b16 a[152:153], v11 offset:6656
ds_read_b64_tr_b16 a[90:91], v9 offset:45056
ds_read_b64_tr_b16 a[154:155], v11 offset:7168
s_add_u32 m0, s60, 122880
s_mov_b32 s58, 5013504
buffer_load_dwordx4 v5, s[28:31], s58 offen lds
ds_read_b64_tr_b16 a[92:93], v10 offset:40960
ds_read_b64_tr_b16 a[156:157], v11 offset:7680
ds_read_b64_tr_b16 a[94:95], v10 offset:45056
ds_read_b64_tr_b16 a[158:159], v11 offset:8192
v_mfma_f32_16x16x32_bf16 v[20:23], a[64:67], v[16:19], v[20:23]
ds_read_b64_tr_b16 a[160:161], v11 offset:8704
s_add_u32 m0, s60, 122880
s_nop 0
buffer_load_dwordx4 v6, s[28:31], s58 offen offset:1024 lds
v_mfma_f32_16x16x32_bf16 v[24:27], a[68:71], v[16:19], v[24:27]
ds_read_b64_tr_b16 a[162:163], v11 offset:9216
v_mfma_f32_16x16x32_bf16 v[20:23], a[72:75], v[16:19], v[20:23]
ds_read_b64_tr_b16 a[164:165], v11 offset:9728
v_mfma_f32_16x16x32_bf16 v[24:27], a[76:79], v[16:19], v[24:27]
ds_read_b64_tr_b16 a[166:167], v11 offset:10240
s_waitcnt vmcnt(8)
s_waitcnt lgkmcnt(0)
s_barrier
ds_read_b64_tr_b16 a[96:97], v9 offset:49152
v_mfma_f32_16x16x32_bf16 v[28:31], a[144:147], v[16:19], 0
v_mfma_f32_16x16x32_bf16 v[28:31], a[148:151], v[16:19], v[28:31]
ds_read_b64_tr_b16 a[98:99], v9 offset:53248
v_mfma_f32_16x16x32_bf16 v[28:31], a[152:155], v[16:19], v[28:31]
ds_read_b64_tr_b16 a[100:101], v10 offset:49152
v_mfma_f32_16x16x32_bf16 v[28:31], a[156:159], v[16:19], v[28:31]
v_mfma_f32_16x16x32_bf16 v[28:31], a[160:163], v[16:19], v[28:31]
ds_read_b64_tr_b16 a[102:103], v10 offset:53248
v_mfma_f32_16x16x32_bf16 v[28:31], a[164:167], v[16:19], v[28:31]
ds_read_b64_tr_b16 a[104:105], v9 offset:57344
ds_read_b64_tr_b16 a[168:169], v11 offset:10752
ds_read_b64_tr_b16 a[170:171], v11 offset:11264
ds_read_b64_tr_b16 a[106:107], v9 offset:61440
ds_read_b64_tr_b16 a[172:173], v11 offset:11776
ds_read_b64_tr_b16 a[108:109], v10 offset:57344
ds_read_b64_tr_b16 a[174:175], v11 offset:12288
ds_read_b64_tr_b16 a[176:177], v11 offset:12800
ds_read_b64_tr_b16 a[110:111], v10 offset:61440
ds_read_b64_tr_b16 a[178:179], v11 offset:13312
v_mfma_f32_16x16x32_bf16 v[20:23], a[80:83], v[16:19], v[20:23]
ds_read_b64_tr_b16 a[180:181], v11 offset:13824
ds_read_b64_tr_b16 a[182:183], v11 offset:14336
v_mfma_f32_16x16x32_bf16 v[24:27], a[84:87], v[16:19], v[24:27]
ds_read_b64_tr_b16 a[184:185], v11 offset:14848
v_mfma_f32_16x16x32_bf16 v[20:23], a[88:91], v[16:19], v[20:23]
ds_read_b64_tr_b16 a[186:187], v11 offset:15360
ds_read_b64_tr_b16 a[188:189], v11 offset:15872
v_mfma_f32_16x16x32_bf16 v[24:27], a[92:95], v[16:19], v[24:27]
ds_read_b64_tr_b16 a[190:191], v11 offset:16384
s_waitcnt vmcnt(4)
s_waitcnt lgkmcnt(0)
s_barrier
ds_read_b64_tr_b16 a[112:113], v9 offset:0
v_mfma_f32_16x16x32_bf16 v[28:31], a[168:171], v[16:19], v[28:31]
v_mfma_f32_16x16x32_bf16 v[28:31], a[172:175], v[16:19], v[28:31]
ds_read_b64_tr_b16 a[114:115], v9 offset:4096
v_mfma_f32_16x16x32_bf16 v[28:31], a[176:179], v[16:19], v[28:31]
ds_read_b64_tr_b16 a[116:117], v10 offset:0
v_mfma_f32_16x16x32_bf16 v[28:31], a[180:183], v[16:19], v[28:31]
v_mfma_f32_16x16x32_bf16 v[28:31], a[184:187], v[16:19], v[28:31]
ds_read_b64_tr_b16 a[118:119], v10 offset:4096
v_mfma_f32_16x16x32_bf16 v[28:31], a[188:191], v[16:19], v[28:31]
ds_read_b64_tr_b16 a[120:121], v9 offset:8192
ds_read_b64_tr_b16 a[192:193], v11 offset:16896
ds_read_b64_tr_b16 a[194:195], v11 offset:17408
ds_read_b64_tr_b16 a[122:123], v9 offset:12288
ds_read_b64_tr_b16 a[196:197], v11 offset:17920
ds_read_b64_tr_b16 a[124:125], v10 offset:8192
ds_read_b64_tr_b16 a[198:199], v11 offset:18432
ds_read_b64_tr_b16 a[200:201], v11 offset:18944
ds_read_b64_tr_b16 a[126:127], v10 offset:12288
ds_read_b64_tr_b16 a[202:203], v11 offset:19456
v_mfma_f32_16x16x32_bf16 v[20:23], a[96:99], v[16:19], v[20:23]
ds_read_b64_tr_b16 a[204:205], v11 offset:19968
ds_read_b64_tr_b16 a[206:207], v11 offset:20480
v_mfma_f32_16x16x32_bf16 v[24:27], a[100:103], v[16:19], v[24:27]
ds_read_b64_tr_b16 a[208:209], v11 offset:20992
v_mfma_f32_16x16x32_bf16 v[20:23], a[104:107], v[16:19], v[20:23]
ds_read_b64_tr_b16 a[210:211], v11 offset:21504
ds_read_b64_tr_b16 a[212:213], v11 offset:22016
v_mfma_f32_16x16x32_bf16 v[24:27], a[108:111], v[16:19], v[24:27]
ds_read_b64_tr_b16 a[214:215], v11 offset:22528
s_waitcnt vmcnt(0)
s_waitcnt lgkmcnt(0)
s_barrier
ds_read_b64_tr_b16 a[128:129], v9 offset:16384
buffer_load_dword v249, v238, s[36:39], 0 offen sc1
ds_read_b64_tr_b16 a[130:131], v9 offset:20480
v_mfma_f32_16x16x32_bf16 v[28:31], a[192:195], v[16:19], v[28:31]
ds_read_b64_tr_b16 a[132:133], v10 offset:16384
ds_read_b64_tr_b16 a[134:135], v10 offset:20480
v_mfma_f32_16x16x32_bf16 v[28:31], a[196:199], v[16:19], v[28:31]
ds_read_b64_tr_b16 a[136:137], v9 offset:24576
ds_read_b64_tr_b16 a[138:139], v9 offset:28672
v_mfma_f32_16x16x32_bf16 v[28:31], a[200:203], v[16:19], v[28:31]
ds_read_b64_tr_b16 a[140:141], v10 offset:24576
v_mfma_f32_16x16x32_bf16 v[28:31], a[204:207], v[16:19], v[28:31]
ds_read_b64_tr_b16 a[142:143], v10 offset:28672
v_mfma_f32_16x16x32_bf16 v[20:23], a[112:115], v[16:19], v[20:23]
v_mfma_f32_16x16x32_bf16 v[28:31], a[208:211], v[16:19], v[28:31]
v_mfma_f32_16x16x32_bf16 v[24:27], a[116:119], v[16:19], v[24:27]
v_mfma_f32_16x16x32_bf16 v[20:23], a[120:123], v[16:19], v[20:23]
v_mfma_f32_16x16x32_bf16 v[28:31], a[212:215], v[16:19], v[28:31]
v_mfma_f32_16x16x32_bf16 v[24:27], a[124:127], v[16:19], v[24:27]
s_waitcnt lgkmcnt(0)
v_mfma_f32_16x16x32_bf16 v[20:23], a[128:131], v[16:19], v[20:23]
v_mfma_f32_16x16x32_bf16 v[24:27], a[132:135], v[16:19], v[24:27]
v_mfma_f32_16x16x32_bf16 v[20:23], a[136:139], v[16:19], v[20:23]
v_mfma_f32_16x16x32_bf16 v[24:27], a[140:143], v[16:19], v[24:27]
s_sub_u32 s54, s51, 0
s_mul_i32 s52, s54, 9216
s_mul_i32 s53, s44, 663552
s_add_u32 s52, s52, s53
s_add_u32 s52, s52, 552960
s_cmp_ge_u32 s54, 12
s_cbranch_scc1 L_35
buffer_load_dword v60, v254, s[32:35], s52 offen
L_35:
s_cmp_lg_u32 s2, 216
s_cbranch_scc1 L_36
v_lshlrev_b32 v56, 7, v0
v_add_u32 v56, 4096, v56
s_mov_b32 s61, 0x40000
L_poll_37:
buffer_load_dword v52, v56, s[36:39], 0 offen sc1
s_sub_u32 s61, s61, 1
s_cbranch_scc1 L_polld_38
s_waitcnt vmcnt(0)
v_cmp_ne_u32 vcc, s49, v52
s_cbranch_vccnz L_poll_37
L_polld_38:
s_barrier
v_mov_b32 v56, 0
s_cmp_lg_u32 s48, 0
s_cbranch_scc1 L_39
buffer_store_dword v14, v56, s[36:39], 0 offen sc1
L_39:
L_36:
L_main:
s_add_u32 s66, s78, s60
s_add_u32 s67, s78, s75
s_mov_b32 s73, 0
s_lshl_b32 s68, s44, 5
s_add_u32 s68, s68, s45
s_lshl_b32 s68, s68, 2
s_add_u32 s68, s68, s48
s_mul_i32 s68, s68, 4608
s_add_u32 s68, s68, 5242880
v_min_u32 v241, 4480, v241
s_add_u32 s81, s81, 73728
s_mov_b32 s55, 18432
s_mov_b32 s56, 36864
s_mov_b32 s57, 55296
s_add_u32 s53, s79, s75
s_mov_b32 s54, 196608
s_add_u32 s82, s79, s71
v_lshlrev_b32 v78, 2, v2
s_lshl_b32 s61, s48, 6
v_add_u32 v78, s61, v78
s_add_u32 m0, s60, 0
s_add_u32 s58, s66, 0
s_waitcnt lgkmcnt(0)
s_waitcnt vmcnt(0)
s_barrier
v_cmp_ne_u32 vcc, s49, v249
s_cbranch_vccnz L_slow_40
L_bak_41:
buffer_load_dwordx4 v4, s[36:39], s58 offen offset:0 sc1 lds
buffer_load_dwordx4 v4, s[36:39], s58 offen offset:1024 sc1 lds
s_add_u32 m0, s75, 8192
s_add_u32 s58, s67, 8192
buffer_load_dwordx4 v4, s[36:39], s58 offen offset:0 sc1 lds
buffer_load_dwordx4 v4, s[36:39], s58 offen offset:1024 sc1 lds
buffer_load_dwordx4 v4, s[36:39], s58 offen offset:2048 sc1 lds
buffer_load_dwordx4 v4, s[36:39], s58 offen offset:3072 sc1 lds
s_waitcnt vmcnt(4)
s_barrier
ds_read_b64 v[52:53], v13 offset:0
ds_read_b64 v[54:55], v13 offset:512
ds_read_b64 v[56:57], v13 offset:1024
ds_read_b64 v[58:59], v13 offset:1536
ds_read_b64 v[60:61], v13 offset:2048
ds_read_b64 v[62:63], v13 offset:2560
ds_read_b64 v[64:65], v13 offset:3072
ds_read_b64 v[66:67], v13 offset:3584
ds_read_b64 v[68:69], v13 offset:4096
s_add_u32 m0, s75, 24576
s_add_u32 s58, s67, 24576
buffer_load_dwordx4 v4, s[36:39], s58 offen offset:0 sc1 lds
s_waitcnt lgkmcnt(0)
v_pk_add_f32 v[52:53], v[52:53], v[54:55]
buffer_load_dwordx4 v4, s[36:39], s58 offen offset:1024 sc1 lds
v_pk_add_f32 v[56:57], v[56:57], v[58:59]
v_pk_add_f32 v[60:61], v[60:61], v[62:63]
v_pk_add_f32 v[64:65], v[64:65], v[66:67]
v_pk_add_f32 v[52:53], v[52:53], v[56:57]
v_pk_add_f32 v[60:61], v[60:61], v[64:65]
v_pk_add_f32 v[52:53], v[52:53], v[60:61]
v_pk_add_f32 v[52:53], v[52:53], v[68:69]
buffer_load_dwordx4 v4, s[36:39], s58 offen offset:2048 sc1 lds
v_mul_f32 v32, 0xbae38e39, v52
v_mul_f32 v53, 0x3ae38e39, v53
v_fma_f32 v53, -v32, v32, v53
v_max_f32 v53, 0, v53
v_add_f32 v53, 0x3727c5ac, v53
v_rsq_f32 v52, v53
v_sqrt_f32 v35, v53
v_mul_f32 v33, s64, v52
buffer_load_dwordx4 v4, s[36:39], s58 offen offset:3072 sc1 lds
v_mul_f32 v53, v52, v52
v_mul_f32 v34, s65, v52
v_mul_f32 v34, v34, v53
ds_bpermute_b32 v244, v78, v32
ds_bpermute_b32 v245, v78, v33
ds_bpermute_b32 v246, v78, v34
ds_bpermute_b32 v247, v78, v35
s_cmp_eq_u32 s59, 0
s_cbranch_scc1 L_stream_remote
s_waitcnt vmcnt(4)
s_barrier
ds_read_b128 v[192:195], v224 offset:0
ds_read_b128 v[196:199], v224 offset:1024
ds_read_b128 v[200:203], v224 offset:2048
ds_read_b128 v[204:207], v224 offset:3072
ds_read_b128 v[208:211], v224 offset:4096
ds_read_b128 v[212:215], v224 offset:5120
s_waitcnt lgkmcnt(5)
v_mfma_f32_16x16x32_bf16 v[80:83], a[0:3], v[192:195], 0
ds_read_b128 v[216:219], v224 offset:6144
v_mov_b32 v40, v32
v_mfma_f32_16x16x32_bf16 v[84:87], a[4:7], v[192:195], 0
s_waitcnt lgkmcnt(5)
v_mov_b32 v41, v33
v_mov_b32 v42, v34
v_mfma_f32_16x16x32_bf16 v[80:83], a[8:11], v[196:199], v[80:83]
s_add_u32 m0, s75, 40960
s_add_u32 s58, s67, 40960
ds_read_b128 v[220:223], v224 offset:7168
v_mfma_f32_16x16x32_bf16 v[84:87], a[12:15], v[196:199], v[84:87]
s_waitcnt lgkmcnt(5)
buffer_load_dwordx4 v4, s[36:39], s58 offen offset:0 sc1 lds
v_mfma_f32_16x16x32_bf16 v[80:83], a[16:19], v[200:203], v[80:83]
ds_read_b128 v[192:195], v224 offset:8192
v_mov_b32 v43, v35
v_mfma_f32_16x16x32_bf16 v[84:87], a[20:23], v[200:203], v[84:87]
s_waitcnt lgkmcnt(5)
v_permlane32_swap_b32 v32, v40
v_permlane32_swap_b32 v33, v41
v_mfma_f32_16x16x32_bf16 v[80:83], a[24:27], v[204:207], v[80:83]
ds_read_b128 v[196:199], v224 offset:9216
v_permlane32_swap_b32 v34, v42
v_mfma_f32_16x16x32_bf16 v[84:87], a[28:31], v[204:207], v[84:87]
s_waitcnt lgkmcnt(5)
v_permlane32_swap_b32 v35, v43
v_mov_b32 v36, v32
v_mfma_f32_16x16x32_bf16 v[80:83], a[32:35], v[208:211], v[80:83]
ds_read_b128 v[200:203], v224 offset:10240
v_mov_b32 v37, v33
v_mfma_f32_16x16x32_bf16 v[84:87], a[36:39], v[208:211], v[84:87]
s_waitcnt lgkmcnt(5)
buffer_load_dwordx4 v4, s[36:39], s58 offen offset:1024 sc1 lds
v_mfma_f32_16x16x32_bf16 v[80:83], a[40:43], v[212:215], v[80:83]
ds_read_b128 v[204:207], v224 offset:11264
v_mov_b32 v38, v34
v_mfma_f32_16x16x32_bf16 v[84:87], a[44:47], v[212:215], v[84:87]
s_waitcnt lgkmcnt(5)
v_mov_b32 v39, v35
v_mov_b32 v44, v40
v_mfma_f32_16x16x32_bf16 v[80:83], a[48:51], v[216:219], v[80:83]
ds_read_b128 v[208:211], v224 offset:12288
v_mov_b32 v45, v41
v_mfma_f32_16x16x32_bf16 v[84:87], a[52:55], v[216:219], v[84:87]
s_waitcnt lgkmcnt(5)
v_mov_b32 v46, v42
v_mov_b32 v47, v43
v_mfma_f32_16x16x32_bf16 v[80:83], a[56:59], v[220:223], v[80:83]
ds_read_b128 v[212:215], v224 offset:13312
v_permlane16_swap_b32 v32, v36
v_mfma_f32_16x16x32_bf16 v[84:87], a[60:63], v[220:223], v[84:87]
s_waitcnt lgkmcnt(5)
buffer_load_dwordx4 v4, s[36:39], s58 offen offset:2048 sc1 lds
v_mfma_f32_16x16x32_bf16 v[80:83], a[64:67], v[192:195], v[80:83]
ds_read_b128 v[216:219], v224 offset:14336
v_permlane16_swap_b32 v33, v37
v_mfma_f32_16x16x32_bf16 v[84:87], a[68:71], v[192:195], v[84:87]
s_waitcnt lgkmcnt(5)
v_permlane16_swap_b32 v34, v38
v_permlane16_swap_b32 v35, v39
v_mfma_f32_16x16x32_bf16 v[80:83], a[72:75], v[196:199], v[80:83]
ds_read_b128 v[220:223], v224 offset:15360
v_permlane16_swap_b32 v40, v44
v_mfma_f32_16x16x32_bf16 v[84:87], a[76:79], v[196:199], v[84:87]
s_waitcnt lgkmcnt(5)
v_permlane16_swap_b32 v41, v45
v_permlane16_swap_b32 v42, v46
v_mfma_f32_16x16x32_bf16 v[80:83], a[80:83], v[200:203], v[80:83]
ds_read_b128 v[192:195], v224 offset:16384
v_permlane16_swap_b32 v43, v47
v_mfma_f32_16x16x32_bf16 v[84:87], a[84:87], v[200:203], v[84:87]
s_waitcnt lgkmcnt(5)
buffer_load_dwordx4 v4, s[36:39], s58 offen offset:3072 sc1 lds
v_mfma_f32_16x16x32_bf16 v[80:83], a[88:91], v[204:207], v[80:83]
ds_read_b128 v[196:199], v224 offset:17408
v_mfma_f32_16x16x32_bf16 v[84:87], a[92:95], v[204:207], v[84:87]
s_waitcnt lgkmcnt(5)
v_mfma_f32_16x16x32_bf16 v[80:83], a[96:99], v[208:211], v[80:83]
ds_read_b128 v[200:203], v224 offset:18432
v_mfma_f32_16x16x32_bf16 v[84:87], a[100:103], v[208:211], v[84:87]
s_waitcnt lgkmcnt(5)
v_mfma_f32_16x16x32_bf16 v[80:83], a[104:107], v[212:215], v[80:83]
s_add_u32 m0, s75, 57344
s_add_u32 s58, s67, 57344
s_waitcnt vmcnt(4)
s_barrier
ds_read_b128 v[204:207], v224 offset:19456
v_mfma_f32_16x16x32_bf16 v[84:87], a[108:111], v[212:215], v[84:87]
s_waitcnt lgkmcnt(5)
buffer_load_dwordx4 v4, s[36:39], s58 offen offset:0 sc1 lds
v_mfma_f32_16x16x32_bf16 v[80:83], a[112:115], v[216:219], v[80:83]
ds_read_b128 v[208:211], v224 offset:20480
v_mfma_f32_16x16x32_bf16 v[84:87], a[116:119], v[216:219], v[84:87]
s_waitcnt lgkmcnt(5)
v_mfma_f32_16x16x32_bf16 v[80:83], a[120:123], v[220:223], v[80:83]
ds_read_b128 v[212:215], v224 offset:21504
v_mfma_f32_16x16x32_bf16 v[84:87], a[124:127], v[220:223], v[84:87]
s_waitcnt lgkmcnt(5)
v_mfma_f32_16x16x32_bf16 v[80:83], a[128:131], v[192:195], v[80:83]
ds_read_b128 v[216:219], v224 offset:22528
v_mfma_f32_16x16x32_bf16 v[84:87], a[132:135], v[192:195], v[84:87]
s_waitcnt lgkmcnt(5)
buffer_load_dwordx4 v4, s[36:39], s58 offen offset:1024 sc1 lds
v_mfma_f32_16x16x32_bf16 v[80:83], a[136:139], v[196:199], v[80:83]
ds_read_b128 v[220:223], v224 offset:23552
v_mfma_f32_16x16x32_bf16 v[84:87], a[140:143], v[196:199], v[84:87]
s_waitcnt lgkmcnt(5)
v_mfma_f32_16x16x32_bf16 v[88:91], a[0:3], v[200:203], 0
ds_read_b128 v[192:195], v224 offset:24576
v_mfma_f32_16x16x32_bf16 v[92:95], a[4:7], v[200:203], 0
s_waitcnt lgkmcnt(5)
v_mfma_f32_16x16x32_bf16 v[88:91], a[8:11], v[204:207], v[88:91]
ds_read_b128 v[196:199], v224 offset:25600
v_mfma_f32_16x16x32_bf16 v[92:95], a[12:15], v[204:207], v[92:95]
s_waitcnt lgkmcnt(5)
buffer_load_dwordx4 v4, s[36:39], s58 offen offset:2048 sc1 lds
v_pk_fma_f32 v[52:53], v[32:33], v[20:21], v[80:81] op_sel_hi:[0,1,1]
v_pk_fma_f32 v[54:55], v[32:33], v[22:23], v[82:83] op_sel_hi:[0,1,1]
v_pk_fma_f32 v[56:57], v[32:33], v[24:25], v[84:85] op_sel_hi:[0,1,1]
v_pk_fma_f32 v[58:59], v[32:33], v[26:27], v[86:87] op_sel_hi:[0,1,1]
v_pk_mul_f32 v[60:61], v[52:53], v[52:53]
v_pk_mul_f32 v[62:63], v[54:55], v[54:55]
v_pk_mul_f32 v[64:65], v[56:57], v[56:57]
v_pk_mul_f32 v[66:67], v[58:59], v[58:59]
v_pk_fma_f32 v[60:61], v[60:61], v[34:35], v[32:33] op_sel:[0,0,1] op_sel_hi:[1,0,1]
v_pk_fma_f32 v[62:63], v[62:63], v[34:35], v[32:33] op_sel:[0,0,1] op_sel_hi:[1,0,1]
v_pk_fma_f32 v[64:65], v[64:65], v[34:35], v[32:33] op_sel:[0,0,1] op_sel_hi:[1,0,1]
v_pk_fma_f32 v[66:67], v[66:67], v[34:35], v[32:33] op_sel:[0,0,1] op_sel_hi:[1,0,1]
v_pk_mul_f32 v[60:61], v[60:61], v[52:53]
v_pk_mul_f32 v[62:63], v[62:63], v[54:55]
v_pk_mul_f32 v[64:65], v[64:65], v[56:57]
v_pk_mul_f32 v[66:67], v[66:67], v[58:59]
v_mfma_f32_16x16x32_bf16 v[88:91], a[16:19], v[208:211], v[88:91]
ds_read_b128 v[200:203], v224 offset:26624
v_exp_f32 v60, v60
v_mfma_f32_16x16x32_bf16 v[92:95], a[20:23], v[208:211], v[92:95]
s_waitcnt lgkmcnt(5)
buffer_load_dwordx4 v4, s[36:39], s58 offen offset:3072 sc1 lds
v_mfma_f32_16x16x32_bf16 v[88:91], a[24:27], v[212:215], v[88:91]
ds_read_b128 v[204:207], v224 offset:27648
v_exp_f32 v61, v61
v_mfma_f32_16x16x32_bf16 v[92:95], a[28:31], v[212:215], v[92:95]
s_waitcnt lgkmcnt(5)
v_exp_f32 v62, v62
v_mfma_f32_16x16x32_bf16 v[88:91], a[32:35], v[216:219], v[88:91]
s_add_u32 m0, s60, 73728
s_add_u32 s58, s66, 73728
ds_read_b128 v[208:211], v224 offset:28672
v_mfma_f32_16x16x32_bf16 v[92:95], a[36:39], v[216:219], v[92:95]
s_waitcnt lgkmcnt(5)
buffer_load_dwordx4 v4, s[36:39], s58 offen offset:0 sc1 lds
v_mfma_f32_16x16x32_bf16 v[88:91], a[40:43], v[220:223], v[88:91]
ds_read_b128 v[212:215], v224 offset:29696
v_exp_f32 v63, v63
v_mfma_f32_16x16x32_bf16 v[92:95], a[44:47], v[220:223], v[92:95]
s_waitcnt lgkmcnt(5)
v_exp_f32 v64, v64
v_mfma_f32_16x16x32_bf16 v[88:91], a[48:51], v[192:195], v[88:91]
ds_read_b128 v[216:219], v224 offset:30720
v_exp_f32 v65, v65
v_mfma_f32_16x16x32_bf16 v[92:95], a[52:55], v[192:195], v[92:95]
s_waitcnt lgkmcnt(5)
v_exp_f32 v66, v66
v_exp_f32 v67, v67
v_pk_fma_f32 v[60:61], v[60:61], v[34:35], v[34:35] op_sel:[0,1,1] op_sel_hi:[1,1,1]
v_pk_fma_f32 v[62:63], v[62:63], v[34:35], v[34:35] op_sel:[0,1,1] op_sel_hi:[1,1,1]
v_pk_fma_f32 v[64:65], v[64:65], v[34:35], v[34:35] op_sel:[0,1,1] op_sel_hi:[1,1,1]
v_pk_fma_f32 v[66:67], v[66:67], v[34:35], v[34:35] op_sel:[0,1,1] op_sel_hi:[1,1,1]
v_mfma_f32_16x16x32_bf16 v[88:91], a[56:59], v[196:199], v[88:91]
ds_read_b128 v[220:223], v224 offset:31744
v_rcp_f32 v60, v60
v_mfma_f32_16x16x32_bf16 v[92:95], a[60:63], v[196:199], v[92:95]
s_waitcnt lgkmcnt(5)
buffer_load_dwordx4 v4, s[36:39], s58 offen offset:1024 sc1 lds
v_mfma_f32_16x16x32_bf16 v[88:91], a[64:67], v[200:203], v[88:91]
ds_read_b128 v[192:195], v224 offset:32768
v_rcp_f32 v61, v61
v_mfma_f32_16x16x32_bf16 v[92:95], a[68:71], v[200:203], v[92:95]
s_waitcnt lgkmcnt(5)
v_rcp_f32 v62, v62
v_mfma_f32_16x16x32_bf16 v[88:91], a[72:75], v[204:207], v[88:91]
ds_read_b128 v[196:199], v224 offset:33792
v_rcp_f32 v63, v63
v_mfma_f32_16x16x32_bf16 v[92:95], a[76:79], v[204:207], v[92:95]
s_waitcnt lgkmcnt(5)
buffer_store_dword v14, v236, s[36:39], 0 offen sc1
v_mfma_f32_16x16x32_bf16 v[88:91], a[80:83], v[208:211], v[88:91]
ds_read_b128 v[200:203], v224 offset:34816
v_rcp_f32 v64, v64
v_mfma_f32_16x16x32_bf16 v[92:95], a[84:87], v[208:211], v[92:95]
s_waitcnt lgkmcnt(5)
buffer_load_dword v252, v241, s[36:39], s68 offen
v_mfma_f32_16x16x32_bf16 v[88:91], a[88:91], v[212:215], v[88:91]
s_waitcnt vmcnt(8)
s_barrier
ds_read_b128 v[204:207], v224 offset:35840
v_mfma_f32_16x16x32_bf16 v[92:95], a[92:95], v[212:215], v[92:95]
s_waitcnt lgkmcnt(5)
v_rcp_f32 v65, v65
v_mfma_f32_16x16x32_bf16 v[88:91], a[96:99], v[216:219], v[88:91]
ds_read_b128 v[208:211], v12 offset:0
v_rcp_f32 v66, v66
v_rcp_f32 v67, v67
v_pk_mul_f32 v[52:53], v[52:53], v[60:61]
v_pk_mul_f32 v[54:55], v[54:55], v[62:63]
v_pk_mul_f32 v[56:57], v[56:57], v[64:65]
v_pk_mul_f32 v[58:59], v[58:59], v[66:67]
v_mfma_f32_16x16x32_bf16 v[92:95], a[100:103], v[216:219], v[92:95]
s_waitcnt lgkmcnt(5)
v_cvt_pk_bf16_f32 v68, v52, v53
v_cvt_pk_bf16_f32 v69, v54, v55
v_cvt_pk_bf16_f32 v70, v56, v57
v_mfma_f32_16x16x32_bf16 v[88:91], a[104:107], v[220:223], v[88:91]
ds_read_b128 v[212:215], v12 offset:1024
v_cvt_pk_bf16_f32 v71, v58, v59
v_mfma_f32_16x16x32_bf16 v[92:95], a[108:111], v[220:223], v[92:95]
s_waitcnt lgkmcnt(5)
buffer_store_dwordx4 v[68:71], v228, s[36:39], 0 offen
v_mfma_f32_16x16x32_bf16 v[88:91], a[112:115], v[192:195], v[88:91]
ds_read_b128 v[216:219], v12 offset:2048
v_mfma_f32_16x16x32_bf16 v[92:95], a[116:119], v[192:195], v[92:95]
s_waitcnt lgkmcnt(5)
v_mfma_f32_16x16x32_bf16 v[88:91], a[120:123], v[196:199], v[88:91]
ds_read_b128 v[220:223], v12 offset:3072
v_mfma_f32_16x16x32_bf16 v[92:95], a[124:127], v[196:199], v[92:95]
s_waitcnt lgkmcnt(5)
v_mfma_f32_16x16x32_bf16 v[88:91], a[128:131], v[200:203], v[88:91]
ds_read_b128 v[192:195], v12 offset:4096
v_mfma_f32_16x16x32_bf16 v[92:95], a[132:135], v[200:203], v[92:95]
s_waitcnt lgkmcnt(5)
v_mfma_f32_16x16x32_bf16 v[88:91], a[136:139], v[204:207], v[88:91]
ds_read_b128 v[196:199], v12 offset:5120
v_mfma_f32_16x16x32_bf16 v[92:95], a[140:143], v[204:207], v[92:95]
s_waitcnt lgkmcnt(5)
v_mfma_f32_16x16x32_bf16 v[96:99], a[0:3], v[208:211], 0
ds_read_b128 v[200:203], v12 offset:6144
v_mfma_f32_16x16x32_bf16 v[100:103], a[4:7], v[208:211], 0
s_waitcnt lgkmcnt(5)
v_mfma_f32_16x16x32_bf16 v[96:99], a[8:11], v[212:215], v[96:99]
ds_read_b128 v[204:207], v12 offset:7168
v_mfma_f32_16x16x32_bf16 v[100:103], a[12:15], v[212:215], v[100:103]
s_waitcnt lgkmcnt(5)
v_pk_fma_f32 v[52:53], v[36:37], v[20:21], v[88:89] op_sel_hi:[0,1,1]
v_pk_fma_f32 v[54:55], v[36:37], v[22:23], v[90:91] op_sel_hi:[0,1,1]
v_pk_fma_f32 v[56:57], v[36:37], v[24:25], v[92:93] op_sel_hi:[0,1,1]
v_pk_fma_f32 v[58:59], v[36:37], v[26:27], v[94:95] op_sel_hi:[0,1,1]
v_pk_mul_f32 v[60:61], v[52:53], v[52:53]
v_pk_mul_f32 v[62:63], v[54:55], v[54:55]
v_pk_mul_f32 v[64:65], v[56:57], v[56:57]
v_pk_mul_f32 v[66:67], v[58:59], v[58:59]
v_pk_fma_f32 v[60:61], v[60:61], v[38:39], v[36:37] op_sel:[0,0,1] op_sel_hi:[1,0,1]
v_pk_fma_f32 v[62:63], v[62:63], v[38:39], v[36:37] op_sel:[0,0,1] op_sel_hi:[1,0,1]
v_pk_fma_f32 v[64:65], v[64:65], v[38:39], v[36:37] op_sel:[0,0,1] op_sel_hi:[1,0,1]
v_pk_fma_f32 v[66:67], v[66:67], v[38:39], v[36:37] op_sel:[0,0,1] op_sel_hi:[1,0,1]
v_pk_mul_f32 v[60:61], v[60:61], v[52:53]
v_pk_mul_f32 v[62:63], v[62:63], v[54:55]
v_pk_mul_f32 v[64:65], v[64:65], v[56:57]
v_pk_mul_f32 v[66:67], v[66:67], v[58:59]
v_mfma_f32_16x16x32_bf16 v[96:99], a[16:19], v[216:219], v[96:99]
ds_read_b128 v[208:211], v12 offset:8192
v_mfma_f32_16x16x32_bf16 v[100:103], a[20:23], v[216:219], v[100:103]
s_waitcnt lgkmcnt(5)
v_exp_f32 v60, v60
v_mfma_f32_16x16x32_bf16 v[96:99], a[24:27], v[220:223], v[96:99]
ds_read_b128 v[212:215], v12 offset:9216
v_mfma_f32_16x16x32_bf16 v[100:103], a[28:31], v[220:223], v[100:103]
s_waitcnt lgkmcnt(5)
v_exp_f32 v61, v61
v_mfma_f32_16x16x32_bf16 v[96:99], a[32:35], v[192:195], v[96:99]
ds_read_b128 v[216:219], v12 offset:10240
v_mfma_f32_16x16x32_bf16 v[100:103], a[36:39], v[192:195], v[100:103]
s_waitcnt lgkmcnt(5)
v_exp_f32 v62, v62
v_mfma_f32_16x16x32_bf16 v[96:99], a[40:43], v[196:199], v[96:99]
ds_read_b128 v[220:223], v12 offset:11264
v_mfma_f32_16x16x32_bf16 v[100:103], a[44:47], v[196:199], v[100:103]
s_waitcnt lgkmcnt(5)
v_exp_f32 v63, v63
v_mfma_f32_16x16x32_bf16 v[96:99], a[48:51], v[200:203], v[96:99]
ds_read_b128 v[192:195], v12 offset:12288
v_mfma_f32_16x16x32_bf16 v[100:103], a[52:55], v[200:203], v[100:103]
s_waitcnt lgkmcnt(5)
v_exp_f32 v64, v64
v_mfma_f32_16x16x32_bf16 v[96:99], a[56:59], v[204:207], v[96:99]
ds_read_b128 v[196:199], v12 offset:13312
v_mfma_f32_16x16x32_bf16 v[100:103], a[60:63], v[204:207], v[100:103]
s_waitcnt lgkmcnt(5)
v_exp_f32 v65, v65
v_mfma_f32_16x16x32_bf16 v[96:99], a[64:67], v[208:211], v[96:99]
ds_read_b128 v[200:203], v12 offset:14336
v_exp_f32 v66, v66
v_exp_f32 v67, v67
v_pk_fma_f32 v[60:61], v[60:61], v[38:39], v[38:39] op_sel:[0,1,1] op_sel_hi:[1,1,1]
v_pk_fma_f32 v[62:63], v[62:63], v[38:39], v[38:39] op_sel:[0,1,1] op_sel_hi:[1,1,1]
v_pk_fma_f32 v[64:65], v[64:65], v[38:39], v[38:39] op_sel:[0,1,1] op_sel_hi:[1,1,1]
v_pk_fma_f32 v[66:67], v[66:67], v[38:39], v[38:39] op_sel:[0,1,1] op_sel_hi:[1,1,1]
v_mfma_f32_16x16x32_bf16 v[100:103], a[68:71], v[208:211], v[100:103]
s_waitcnt lgkmcnt(5)
v_rcp_f32 v60, v60
v_mfma_f32_16x16x32_bf16 v[96:99], a[72:75], v[212:215], v[96:99]
s_waitcnt vmcnt(5)
s_barrier
ds_read_b128 v[204:207], v12 offset:15360
v_mfma_f32_16x16x32_bf16 v[100:103], a[76:79], v[212:215], v[100:103]
s_waitcnt lgkmcnt(5)
v_rcp_f32 v61, v61
v_mfma_f32_16x16x32_bf16 v[96:99], a[80:83], v[216:219], v[96:99]
s_waitcnt vmcnt(0)
buffer_store_dword v14, v230, s[36:39], 0 offen offset:0
ds_read_b128 v[208:211], v12 offset:16384
v_mfma_f32_16x16x32_bf16 v[100:103], a[84:87], v[216:219], v[100:103]
s_waitcnt lgkmcnt(5)
v_rcp_f32 v62, v62
v_mfma_f32_16x16x32_bf16 v[96:99], a[88:91], v[220:223], v[96:99]
ds_read_b128 v[212:215], v12 offset:17408
v_mfma_f32_16x16x32_bf16 v[100:103], a[92:95], v[220:223], v[100:103]
s_waitcnt lgkmcnt(5)
v_rcp_f32 v63, v63
v_mfma_f32_16x16x32_bf16 v[96:99], a[96:99], v[192:195], v[96:99]
s_add_u32 m0, s60, 98304
s_barrier
ds_read_b128 v[48:51], v233
ds_read_b128 v[216:219], v232 offset:0
v_mfma_f32_16x16x32_bf16 v[100:103], a[100:103], v[192:195], v[100:103]
s_waitcnt lgkmcnt(6)
buffer_load_dwordx4 v7, s[32:35], s73 offen lds
v_mfma_f32_16x16x32_bf16 v[96:99], a[104:107], v[196:199], v[96:99]
ds_read_b128 v[220:223], v232 offset:1024
v_mfma_f32_16x16x32_bf16 v[100:103], a[108:111], v[196:199], v[100:103]
s_waitcnt lgkmcnt(6)
v_rcp_f32 v64, v64
v_mfma_f32_16x16x32_bf16 v[96:99], a[112:115], v[200:203], v[96:99]
s_mov_b32 s74, 36864
ds_read_b128 v[192:195], v232 offset:2048
v_mfma_f32_16x16x32_bf16 v[100:103], a[116:119], v[200:203], v[100:103]
s_waitcnt lgkmcnt(6)
buffer_load_dwordx4 v8, s[32:35], s73 offen offset:1024 lds
v_mfma_f32_16x16x32_bf16 v[96:99], a[120:123], v[204:207], v[96:99]
ds_read_b128 v[196:199], v232 offset:3072
v_mfma_f32_16x16x32_bf16 v[100:103], a[124:127], v[204:207], v[100:103]
s_waitcnt lgkmcnt(6)
v_rcp_f32 v65, v65
v_mfma_f32_16x16x32_bf16 v[96:99], a[128:131], v[208:211], v[96:99]
s_add_u32 m0, s60, 106496
ds_read_b128 v[200:203], v232 offset:4096
v_rcp_f32 v66, v66
v_rcp_f32 v67, v67
v_pk_mul_f32 v[52:53], v[52:53], v[60:61]
v_pk_mul_f32 v[54:55], v[54:55], v[62:63]
v_pk_mul_f32 v[56:57], v[56:57], v[64:65]
v_pk_mul_f32 v[58:59], v[58:59], v[66:67]
v_mfma_f32_16x16x32_bf16 v[100:103], a[132:135], v[208:211], v[100:103]
s_waitcnt lgkmcnt(6)
buffer_load_dwordx4 v7, s[32:35], s74 offen lds
buffer_load_dword v248, v231, s[36:39], 0 offen offset:0 sc1
v_mfma_f32_16x16x32_bf16 v[96:99], a[136:139], v[212:215], v[96:99]
s_mov_b32 s73, 73728
ds_read_b128 v[204:207], v232 offset:5120
v_cvt_pk_bf16_f32 v68, v52, v53
v_mfma_f32_16x16x32_bf16 v[100:103], a[140:143], v[212:215], v[100:103]
s_waitcnt lgkmcnt(5)
buffer_load_dwordx4 v8, s[32:35], s74 offen offset:1024 lds
v_mfma_f32_16x16x32_bf16 v[112:115], a[144:147], v[216:219], 0
s_waitcnt lgkmcnt(4)
ds_read_b128 v[208:211], v232 offset:6144
v_cvt_pk_bf16_f32 v69, v54, v55
v_mfma_f32_16x16x32_bf16 v[112:115], a[148:151], v[220:223], v[112:115]
s_waitcnt lgkmcnt(4)
ds_read_b128 v[212:215], v232 offset:7168
v_cvt_pk_bf16_f32 v70, v56, v57
v_cvt_pk_bf16_f32 v71, v58, v59
v_mfma_f32_16x16x32_bf16 v[112:115], a[152:155], v[192:195], v[112:115]
s_add_u32 m0, s60, 114688
s_waitcnt lgkmcnt(4)
buffer_store_dwordx4 v[68:71], v228, s[36:39], s55 offen
ds_read_b128 v[216:219], v232 offset:8192
v_mfma_f32_16x16x32_bf16 v[112:115], a[156:159], v[196:199], v[112:115]
s_waitcnt lgkmcnt(4)
buffer_load_dwordx4 v7, s[32:35], s73 offen lds
ds_read_b128 v[220:223], v232 offset:9216
v_pk_fma_f32 v[52:53], v[40:41], v[20:21], v[96:97] op_sel_hi:[0,1,1]
v_pk_fma_f32 v[54:55], v[40:41], v[22:23], v[98:99] op_sel_hi:[0,1,1]
v_pk_fma_f32 v[56:57], v[40:41], v[24:25], v[100:101] op_sel_hi:[0,1,1]
v_pk_fma_f32 v[58:59], v[40:41], v[26:27], v[102:103] op_sel_hi:[0,1,1]
v_pk_mul_f32 v[60:61], v[52:53], v[52:53]
v_pk_mul_f32 v[62:63], v[54:55], v[54:55]
v_pk_mul_f32 v[64:65], v[56:57], v[56:57]
v_pk_mul_f32 v[66:67], v[58:59], v[58:59]
v_pk_fma_f32 v[60:61], v[60:61], v[42:43], v[40:41] op_sel:[0,0,1] op_sel_hi:[1,0,1]
v_pk_fma_f32 v[62:63], v[62:63], v[42:43], v[40:41] op_sel:[0,0,1] op_sel_hi:[1,0,1]
v_pk_fma_f32 v[64:65], v[64:65], v[42:43], v[40:41] op_sel:[0,0,1] op_sel_hi:[1,0,1]
v_pk_fma_f32 v[66:67], v[66:67], v[42:43], v[40:41] op_sel:[0,0,1] op_sel_hi:[1,0,1]
v_pk_mul_f32 v[60:61], v[60:61], v[52:53]
v_pk_mul_f32 v[62:63], v[62:63], v[54:55]
v_pk_mul_f32 v[64:65], v[64:65], v[56:57]
v_pk_mul_f32 v[66:67], v[66:67], v[58:59]
v_mfma_f32_16x16x32_bf16 v[112:115], a[160:163], v[200:203], v[112:115]
s_mov_b32 s74, 110592
s_waitcnt lgkmcnt(4)
ds_read_b128 v[192:195], v232 offset:10240
v_mfma_f32_16x16x32_bf16 v[112:115], a[164:167], v[204:207], v[112:115]
s_waitcnt lgkmcnt(4)
buffer_load_dwordx4 v8, s[32:35], s73 offen offset:1024 lds
ds_read_b128 v[196:199], v232 offset:11264
v_mfma_f32_16x16x32_bf16 v[112:115], a[168:171], v[208:211], v[112:115]
s_waitcnt lgkmcnt(4)
ds_read_b128 v[200:203], v232 offset:12288
v_mfma_f32_16x16x32_bf16 v[112:115], a[172:175], v[212:215], v[112:115]
s_waitcnt lgkmcnt(4)
ds_read_b128 v[204:207], v232 offset:13312
v_exp_f32 v60, v60
v_mfma_f32_16x16x32_bf16 v[112:115], a[176:179], v[216:219], v[112:115]
s_add_u32 m0, s60, 122880
s_waitcnt lgkmcnt(4)
ds_read_b128 v[208:211], v232 offset:14336
v_mfma_f32_16x16x32_bf16 v[112:115], a[180:183], v[220:223], v[112:115]
s_waitcnt lgkmcnt(4)
buffer_load_dwordx4 v7, s[32:35], s74 offen lds
ds_read_b128 v[212:215], v232 offset:15360
v_mfma_f32_16x16x32_bf16 v[112:115], a[184:187], v[192:195], v[112:115]
s_waitcnt lgkmcnt(4)
ds_read_b128 v[216:219], v232 offset:16384
v_mfma_f32_16x16x32_bf16 v[112:115], a[188:191], v[196:199], v[112:115]
s_waitcnt lgkmcnt(4)
ds_read_b128 v[220:223], v232 offset:17408
v_exp_f32 v61, v61
v_mfma_f32_16x16x32_bf16 v[112:115], a[192:195], v[200:203], v[112:115]
s_mov_b32 s73, 147456
s_waitcnt lgkmcnt(4)
ds_read_b128 v[192:195], v12 offset:18432
v_mfma_f32_16x16x32_bf16 v[112:115], a[196:199], v[204:207], v[112:115]
s_waitcnt lgkmcnt(4)
buffer_load_dwordx4 v8, s[32:35], s74 offen offset:1024 lds
ds_read_b128 v[196:199], v12 offset:19456
v_mfma_f32_16x16x32_bf16 v[112:115], a[200:203], v[208:211], v[112:115]
s_waitcnt lgkmcnt(4)
ds_read_b128 v[200:203], v12 offset:20480
v_mfma_f32_16x16x32_bf16 v[112:115], a[204:207], v[212:215], v[112:115]
s_waitcnt lgkmcnt(4)
ds_read_b128 v[204:207], v12 offset:21504
v_exp_f32 v62, v62
v_mfma_f32_16x16x32_bf16 v[112:115], a[208:211], v[216:219], v[112:115]
s_add_u32 m0, s60, 131072
s_waitcnt lgkmcnt(4)
ds_read_b128 v[208:211], v12 offset:22528
v_mfma_f32_16x16x32_bf16 v[112:115], a[212:215], v[220:223], v[112:115]
s_waitcnt lgkmcnt(4)
buffer_load_dwordx4 v7, s[32:35], s73 offen lds
ds_read_b128 v[212:215], v12 offset:23552
v_mfma_f32_16x16x32_bf16 v[104:107], a[0:3], v[192:195], 0
ds_read_b128 v[216:219], v12 offset:24576
s_waitcnt vmcnt(7)
v_cmp_ne_u32 vcc, s49, v248
v_mfma_f32_16x16x32_bf16 v[108:111], a[4:7], v[192:195], 0
s_waitcnt lgkmcnt(5)
s_cbranch_vccnz L_slow_43
L_bak_44:
s_barrier
v_mfma_f32_16x16x32_bf16 v[104:107], a[8:11], v[196:199], v[104:107]
s_mov_b32 s74, 184320
ds_read_b128 v[220:223], v12 offset:25600
v_mfma_f32_16x16x32_bf16 v[108:111], a[12:15], v[196:199], v[108:111]
s_waitcnt lgkmcnt(5)
buffer_load_dwordx4 v8, s[32:35], s73 offen offset:1024 lds
v_mfma_f32_16x16x32_bf16 v[104:107], a[16:19], v[200:203], v[104:107]
ds_read_b128 v[192:195], v12 offset:26624
v_mfma_f32_16x16x32_bf16 v[108:111], a[20:23], v[200:203], v[108:111]
s_waitcnt lgkmcnt(5)
v_exp_f32 v63, v63
v_mfma_f32_16x16x32_bf16 v[104:107], a[24:27], v[204:207], v[104:107]
s_add_u32 m0, s75, 4608
s_add_u32 s52, s53, 0
ds_read_b128 v[196:199], v12 offset:27648
v_mfma_f32_16x16x32_bf16 v[108:111], a[28:31], v[204:207], v[108:111]
s_waitcnt lgkmcnt(5)
buffer_load_dwordx4 v4, s[36:39], s52 offen offset:0 sc1 lds
v_mfma_f32_16x16x32_bf16 v[104:107], a[32:35], v[208:211], v[104:107]
ds_read_b128 v[200:203], v12 offset:28672
v_mfma_f32_16x16x32_bf16 v[108:111], a[36:39], v[208:211], v[108:111]
s_waitcnt lgkmcnt(5)
v_exp_f32 v64, v64
v_mfma_f32_16x16x32_bf16 v[104:107], a[40:43], v[212:215], v[104:107]
ds_read_b128 v[204:207], v12 offset:29696
v_mfma_f32_16x16x32_bf16 v[108:111], a[44:47], v[212:215], v[108:111]
s_waitcnt lgkmcnt(5)
buffer_load_dwordx4 v4, s[36:39], s52 offen offset:1024 sc1 lds
v_mfma_f32_16x16x32_bf16 v[104:107], a[48:51], v[216:219], v[104:107]
s_waitcnt vmcnt(8)
buffer_store_dword v14, v230, s[36:39], 0 offen offset:128
ds_read_b128 v[208:211], v12 offset:30720
v_mfma_f32_16x16x32_bf16 v[108:111], a[52:55], v[216:219], v[108:111]
s_waitcnt lgkmcnt(5)
v_exp_f32 v65, v65
v_mfma_f32_16x16x32_bf16 v[104:107], a[56:59], v[220:223], v[104:107]
ds_read_b128 v[212:215], v12 offset:31744
v_exp_f32 v66, v66
v_exp_f32 v67, v67
v_pk_fma_f32 v[60:61], v[60:61], v[42:43], v[42:43] op_sel:[0,1,1] op_sel_hi:[1,1,1]
v_pk_fma_f32 v[62:63], v[62:63], v[42:43], v[42:43] op_sel:[0,1,1] op_sel_hi:[1,1,1]
v_pk_fma_f32 v[64:65], v[64:65], v[42:43], v[42:43] op_sel:[0,1,1] op_sel_hi:[1,1,1]
v_pk_fma_f32 v[66:67], v[66:67], v[42:43], v[42:43] op_sel:[0,1,1] op_sel_hi:[1,1,1]
v_mfma_f32_16x16x32_bf16 v[108:111], a[60:63], v[220:223], v[108:111]
s_waitcnt lgkmcnt(5)
buffer_load_dwordx4 v4, s[36:39], s52 offen offset:2048 sc1 lds
s_waitcnt vmcnt(6)
s_barrier
v_mfma_f32_16x16x32_bf16 v[104:107], a[64:67], v[192:195], v[104:107]
ds_read_b128 v[216:219], v12 offset:32768
ds_read_b64_tr_b16 a[216:217], v9 offset:0
v_mfma_f32_16x16x32_bf16 v[108:111], a[68:71], v[192:195], v[108:111]
s_waitcnt lgkmcnt(6)
buffer_load_dwordx4 v4, s[36:39], s52 offen offset:3072 sc1 lds
ds_read_b64_tr_b16 a[218:219], v9 offset:4096
v_mfma_f32_16x16x32_bf16 v[104:107], a[72:75], v[196:199], v[104:107]
ds_read_b128 v[220:223], v12 offset:33792
ds_read_b64_tr_b16 a[220:221], v10 offset:0
v_mfma_f32_16x16x32_bf16 v[108:111], a[76:79], v[196:199], v[108:111]
s_waitcnt lgkmcnt(8)
ds_read_b64_tr_b16 a[222:223], v10 offset:4096
ds_read_b64_tr_b16 a[224:225], v9 offset:8192
ds_read_b64_tr_b16 a[226:227], v9 offset:12288
v_mfma_f32_16x16x32_bf16 v[104:107], a[80:83], v[200:203], v[104:107]
s_add_u32 m0, s60, 139264
ds_read_b128 v[192:195], v12 offset:34816
ds_read_b64_tr_b16 a[228:229], v10 offset:8192
v_mfma_f32_16x16x32_bf16 v[108:111], a[84:87], v[200:203], v[108:111]
s_waitcnt lgkmcnt(12)
buffer_load_dwordx4 v7, s[32:35], s74 offen lds
ds_read_b64_tr_b16 a[230:231], v10 offset:12288
v_mfma_f32_16x16x32_bf16 v[104:107], a[88:91], v[204:207], v[104:107]
ds_read_b128 v[196:199], v12 offset:35840
ds_read_b64_tr_b16 a[232:233], v9 offset:16384
v_mfma_f32_16x16x32_bf16 v[108:111], a[92:95], v[204:207], v[108:111]
s_waitcnt lgkmcnt(14)
ds_read_b64_tr_b16 a[234:235], v9 offset:20480
ds_read_b64_tr_b16 a[236:237], v10 offset:16384
ds_read_b64_tr_b16 a[238:239], v10 offset:20480
v_mfma_f32_16x16x32_bf16 v[104:107], a[96:99], v[208:211], v[104:107]
s_mov_b32 s73, 221184
buffer_load_dword v249, v231, s[36:39], 0 offen offset:128 sc1
v_mfma_f32_16x16x32_bf16 v[108:111], a[100:103], v[208:211], v[108:111]
s_waitcnt lgkmcnt(15)
buffer_load_dwordx4 v8, s[32:35], s74 offen offset:1024 lds
ds_read_b64_tr_b16 a[240:241], v9 offset:24576
v_mfma_f32_16x16x32_bf16 v[104:107], a[104:107], v[212:215], v[104:107]
ds_read_b64_tr_b16 a[242:243], v9 offset:28672
ds_read_b64_tr_b16 a[244:245], v10 offset:24576
v_mfma_f32_16x16x32_bf16 v[108:111], a[108:111], v[212:215], v[108:111]
ds_read_b64_tr_b16 a[246:247], v10 offset:28672
v_rcp_f32 v60, v60
v_mfma_f32_16x16x32_bf16 v[104:107], a[112:115], v[216:219], v[104:107]
s_add_u32 m0, s60, 147456
s_nop 0
buffer_load_dwordx4 v7, s[32:35], s73 offen lds
v_rcp_f32 v61, v61
v_rcp_f32 v62, v62
v_rcp_f32 v63, v63
v_rcp_f32 v64, v64
v_rcp_f32 v65, v65
v_rcp_f32 v66, v66
v_rcp_f32 v67, v67
v_pk_mul_f32 v[52:53], v[52:53], v[60:61]
v_pk_mul_f32 v[54:55], v[54:55], v[62:63]
v_pk_mul_f32 v[56:57], v[56:57], v[64:65]
v_pk_mul_f32 v[58:59], v[58:59], v[66:67]
s_mov_b32 s74, 258048
s_nop 0
buffer_load_dwordx4 v8, s[32:35], s73 offen offset:1024 lds
v_cvt_pk_bf16_f32 v68, v52, v53
v_cvt_pk_bf16_f32 v69, v54, v55
v_cvt_pk_bf16_f32 v70, v56, v57
v_cvt_pk_bf16_f32 v71, v58, v59
buffer_store_dwordx4 v[68:71], v228, s[36:39], s56 offen
v_pk_fma_f32 v[52:53], v[244:245], v[28:29], v[112:113] op_sel_hi:[0,1,1]
v_pk_fma_f32 v[54:55], v[244:245], v[30:31], v[114:115] op_sel_hi:[0,1,1]
v_pk_mul_f32 v[60:61], v[52:53], v[52:53]
v_pk_mul_f32 v[62:63], v[54:55], v[54:55]
v_pk_fma_f32 v[60:61], v[60:61], v[246:247], v[244:245] op_sel:[0,0,1] op_sel_hi:[1,0,1]
v_pk_fma_f32 v[62:63], v[62:63], v[246:247], v[244:245] op_sel:[0,0,1] op_sel_hi:[1,0,1]
v_pk_mul_f32 v[60:61], v[60:61], v[52:53]
v_pk_mul_f32 v[62:63], v[62:63], v[54:55]
v_exp_f32 v60, v60
v_exp_f32 v61, v61
v_exp_f32 v62, v62
v_exp_f32 v63, v63
v_pk_fma_f32 v[60:61], v[60:61], v[246:247], v[246:247] op_sel:[0,1,1] op_sel_hi:[1,1,1]
v_pk_fma_f32 v[62:63], v[62:63], v[246:247], v[246:247] op_sel:[0,1,1] op_sel_hi:[1,1,1]
v_rcp_f32 v60, v60
s_waitcnt vmcnt(6)
s_barrier
ds_read_b128 v[200:203], v224 offset:0
ds_read_b128 v[204:207], v224 offset:1024
s_add_u32 m0, s60, 155648
v_rcp_f32 v61, v61
v_mfma_f32_16x16x32_bf16 v[108:111], a[116:119], v[216:219], v[108:111]
s_waitcnt lgkmcnt(15)
buffer_load_dwordx4 v7, s[32:35], s74 offen lds
s_waitcnt vmcnt(5)
v_cmp_ne_u32 vcc, s49, v249
v_mfma_f32_16x16x32_bf16 v[104:107], a[120:123], v[220:223], v[104:107]
s_cbranch_vccnz L_slow_46
L_bak_47:
ds_read_b128 v[208:211], v224 offset:2048
ds_read_b128 v[212:215], v224 offset:3072
v_mfma_f32_16x16x32_bf16 v[108:111], a[124:127], v[220:223], v[108:111]
s_waitcnt lgkmcnt(15)
v_rcp_f32 v62, v62
v_rcp_f32 v63, v63
v_pk_mul_f32 v[52:53], v[52:53], v[60:61]
v_pk_mul_f32 v[54:55], v[54:55], v[62:63]
v_mfma_f32_16x16x32_bf16 v[104:107], a[128:131], v[192:195], v[104:107]
s_mov_b32 s73, 294912
v_cvt_pk_bf16_f32 v72, v52, v53
v_cvt_pk_bf16_f32 v73, v54, v55
v_mfma_f32_16x16x32_bf16 v[108:111], a[132:135], v[192:195], v[108:111]
s_waitcnt lgkmcnt(12)
buffer_load_dwordx4 v8, s[32:35], s74 offen offset:1024 lds
buffer_store_dwordx2 v[72:73], v229, s[36:39], 0 offen
v_mfma_f32_16x16x32_bf16 v[104:107], a[136:139], v[196:199], v[104:107]
v_mfma_f32_16x16x32_bf16 v[108:111], a[140:143], v[196:199], v[108:111]
s_waitcnt lgkmcnt(3)
v_mfma_f32_16x16x32_bf16 v[156:159], a[216:219], v[200:203], 0
s_add_u32 m0, s75, 23040
s_add_u32 s52, s53, 18432
s_nop 0
buffer_load_dwordx4 v4, s[36:39], s52 offen offset:0 sc1 lds
buffer_load_dwordx4 v4, s[36:39], s52 offen offset:1024 sc1 lds
buffer_load_dwordx4 v4, s[36:39], s52 offen offset:2048 sc1 lds
buffer_load_dwordx4 v4, s[36:39], s52 offen offset:3072 sc1 lds
s_waitcnt vmcnt(5)
s_barrier
ds_read_b64_tr_b16 a[248:249], v9 offset:32768
ds_read_b64_tr_b16 a[250:251], v9 offset:36864
ds_read_b64_tr_b16 a[252:253], v10 offset:32768
s_add_u32 m0, s60, 81920
s_nop 0
buffer_load_dwordx4 v7, s[32:35], s73 offen lds
buffer_store_dword v14, v230, s[36:39], 0 offen offset:256
ds_read_b64_tr_b16 a[254:255], v10 offset:36864
ds_read_b64_tr_b16 v[116:117], v9 offset:40960
ds_read_b64_tr_b16 v[118:119], v9 offset:45056
ds_read_b64_tr_b16 v[120:121], v10 offset:40960
ds_read_b64_tr_b16 v[122:123], v10 offset:45056
ds_read_b64_tr_b16 v[124:125], v9 offset:49152
ds_read_b64_tr_b16 v[126:127], v9 offset:53248
ds_read_b64_tr_b16 v[128:129], v10 offset:49152
ds_read_b64_tr_b16 v[130:131], v10 offset:53248
ds_read_b64_tr_b16 v[132:133], v9 offset:57344
ds_read_b64_tr_b16 v[134:135], v9 offset:61440
ds_read_b64_tr_b16 v[136:137], v10 offset:57344
s_mov_b32 s74, 331776
s_nop 0
buffer_load_dwordx4 v8, s[32:35], s73 offen offset:1024 lds
ds_read_b64_tr_b16 v[138:139], v10 offset:61440
ds_read_b128 v[216:219], v224 offset:4096
ds_read_b128 v[220:223], v224 offset:5120
v_mfma_f32_16x16x32_bf16 v[160:163], a[220:223], v[200:203], 0
s_waitcnt lgkmcnt(15)
v_mfma_f32_16x16x32_bf16 v[156:159], a[224:227], v[204:207], v[156:159]
ds_read_b128 v[192:195], v224 offset:6144
ds_read_b128 v[196:199], v224 offset:7168
v_mfma_f32_16x16x32_bf16 v[160:163], a[228:231], v[204:207], v[160:163]
v_pk_fma_f32 v[52:53], v[44:45], v[20:21], v[104:105] op_sel_hi:[0,1,1]
v_pk_fma_f32 v[54:55], v[44:45], v[22:23], v[106:107] op_sel_hi:[0,1,1]
v_pk_fma_f32 v[56:57], v[44:45], v[24:25], v[108:109] op_sel_hi:[0,1,1]
v_pk_fma_f32 v[58:59], v[44:45], v[26:27], v[110:111] op_sel_hi:[0,1,1]
v_pk_mul_f32 v[60:61], v[52:53], v[52:53]
v_pk_mul_f32 v[62:63], v[54:55], v[54:55]
v_pk_mul_f32 v[64:65], v[56:57], v[56:57]
v_pk_mul_f32 v[66:67], v[58:59], v[58:59]
v_pk_fma_f32 v[60:61], v[60:61], v[46:47], v[44:45] op_sel:[0,0,1] op_sel_hi:[1,0,1]
v_pk_fma_f32 v[62:63], v[62:63], v[46:47], v[44:45] op_sel:[0,0,1] op_sel_hi:[1,0,1]
v_pk_fma_f32 v[64:65], v[64:65], v[46:47], v[44:45] op_sel:[0,0,1] op_sel_hi:[1,0,1]
v_pk_fma_f32 v[66:67], v[66:67], v[46:47], v[44:45] op_sel:[0,0,1] op_sel_hi:[1,0,1]
v_pk_mul_f32 v[60:61], v[60:61], v[52:53]
v_pk_mul_f32 v[62:63], v[62:63], v[54:55]
v_pk_mul_f32 v[64:65], v[64:65], v[56:57]
v_pk_mul_f32 v[66:67], v[66:67], v[58:59]
v_mfma_f32_16x16x32_bf16 v[156:159], a[232:235], v[208:211], v[156:159]
s_add_u32 m0, s60, 90112
s_waitcnt vmcnt(7)
buffer_store_dword v14, v230, s[36:39], 0 offen offset:512
v_mfma_f32_16x16x32_bf16 v[160:163], a[236:239], v[208:211], v[160:163]
buffer_load_dwordx4 v7, s[32:35], s74 offen lds
v_exp_f32 v60, v60
v_mfma_f32_16x16x32_bf16 v[156:159], a[240:243], v[212:215], v[156:159]
s_mov_b32 s73, 368640
buffer_load_dword v250, v231, s[36:39], 0 offen offset:256 sc1
s_waitcnt lgkmcnt(4)
s_barrier
v_mfma_f32_16x16x32_bf16 v[160:163], a[244:247], v[212:215], v[160:163]
s_waitcnt lgkmcnt(3)
buffer_load_dwordx4 v8, s[32:35], s74 offen offset:1024 lds
v_exp_f32 v61, v61
v_mfma_f32_16x16x32_bf16 v[156:159], a[248:251], v[216:219], v[156:159]
s_add_u32 m0, s60, 98304
s_waitcnt vmcnt(7)
s_barrier
ds_read_b128 v[200:203], v224 offset:18432
ds_read_b128 v[204:207], v224 offset:19456
v_mfma_f32_16x16x32_bf16 v[160:163], a[252:255], v[216:219], v[160:163]
s_waitcnt lgkmcnt(4)
buffer_load_dwordx4 v7, s[32:35], s73 offen lds
v_exp_f32 v62, v62
v_mfma_f32_16x16x32_bf16 v[156:159], v[116:119], v[220:223], v[156:159]
s_mov_b32 s74, 405504
ds_read_b128 v[208:211], v224 offset:20480
ds_read_b128 v[212:215], v224 offset:21504
v_exp_f32 v63, v63
v_mfma_f32_16x16x32_bf16 v[160:163], v[120:123], v[220:223], v[160:163]
s_waitcnt lgkmcnt(5)
buffer_load_dwordx4 v8, s[32:35], s73 offen offset:1024 lds
v_exp_f32 v64, v64
v_mfma_f32_16x16x32_bf16 v[156:159], v[124:127], v[192:195], v[156:159]
ds_read_b128 v[216:219], v224 offset:22528
v_exp_f32 v65, v65
v_mfma_f32_16x16x32_bf16 v[160:163], v[128:131], v[192:195], v[160:163]
s_waitcnt lgkmcnt(5)
v_exp_f32 v66, v66
v_exp_f32 v67, v67
v_pk_fma_f32 v[60:61], v[60:61], v[46:47], v[46:47] op_sel:[0,1,1] op_sel_hi:[1,1,1]
v_pk_fma_f32 v[62:63], v[62:63], v[46:47], v[46:47] op_sel:[0,1,1] op_sel_hi:[1,1,1]
v_pk_fma_f32 v[64:65], v[64:65], v[46:47], v[46:47] op_sel:[0,1,1] op_sel_hi:[1,1,1]
v_pk_fma_f32 v[66:67], v[66:67], v[46:47], v[46:47] op_sel:[0,1,1] op_sel_hi:[1,1,1]
v_mfma_f32_16x16x32_bf16 v[156:159], v[132:135], v[196:199], v[156:159]
s_add_u32 m0, s60, 106496
buffer_load_dword v252, v231, s[36:39], 0 offen offset:512 sc1
ds_read_b128 v[220:223], v224 offset:23552
v_mfma_f32_16x16x32_bf16 v[160:163], v[136:139], v[196:199], v[160:163]
s_waitcnt lgkmcnt(5)
buffer_load_dwordx4 v7, s[32:35], s74 offen lds
v_rcp_f32 v60, v60
v_mfma_f32_16x16x32_bf16 v[164:167], a[216:219], v[200:203], 0
s_mov_b32 s73, 442368
ds_read_b128 v[192:195], v224 offset:24576
v_rcp_f32 v61, v61
v_mfma_f32_16x16x32_bf16 v[168:171], a[220:223], v[200:203], 0
s_waitcnt lgkmcnt(5)
buffer_load_dwordx4 v8, s[32:35], s74 offen offset:1024 lds
s_waitcnt vmcnt(6)
v_cmp_ne_u32 vcc, s49, v250
v_mfma_f32_16x16x32_bf16 v[164:167], a[224:227], v[204:207], v[164:167]
s_cbranch_vccnz L_slow_49
L_bak_50:
ds_read_b128 v[196:199], v224 offset:25600
v_mfma_f32_16x16x32_bf16 v[168:171], a[228:231], v[204:207], v[168:171]
s_waitcnt lgkmcnt(5)
v_rcp_f32 v62, v62
v_rcp_f32 v63, v63
v_mfma_f32_16x16x32_bf16 v[164:167], a[232:235], v[208:211], v[164:167]
s_add_u32 m0, s75, 41472
s_add_u32 s52, s53, 36864
v_rcp_f32 v64, v64
v_mfma_f32_16x16x32_bf16 v[168:171], a[236:239], v[208:211], v[168:171]
s_waitcnt lgkmcnt(4)
buffer_load_dwordx4 v4, s[36:39], s52 offen offset:0 sc1 lds
v_rcp_f32 v65, v65
v_mfma_f32_16x16x32_bf16 v[164:167], a[240:243], v[212:215], v[164:167]
v_rcp_f32 v66, v66
v_rcp_f32 v67, v67
v_pk_mul_f32 v[52:53], v[52:53], v[60:61]
v_pk_mul_f32 v[54:55], v[54:55], v[62:63]
v_pk_mul_f32 v[56:57], v[56:57], v[64:65]
v_pk_mul_f32 v[58:59], v[58:59], v[66:67]
v_mfma_f32_16x16x32_bf16 v[168:171], a[244:247], v[212:215], v[168:171]
s_waitcnt lgkmcnt(3)
buffer_load_dwordx4 v4, s[36:39], s52 offen offset:1024 sc1 lds
v_cvt_pk_bf16_f32 v68, v52, v53
v_cvt_pk_bf16_f32 v69, v54, v55
v_mfma_f32_16x16x32_bf16 v[164:167], a[248:251], v[216:219], v[164:167]
v_cvt_pk_bf16_f32 v70, v56, v57
v_cvt_pk_bf16_f32 v71, v58, v59
buffer_load_dwordx4 v4, s[36:39], s52 offen offset:2048 sc1 lds
buffer_store_dwordx4 v[68:71], v228, s[36:39], s57 offen
s_waitcnt vmcnt(6)
v_cmp_ne_u32 vcc, s49, v252
s_cbranch_vccnz L_slow_55
L_bak_56:
buffer_load_dwordx4 v4, s[36:39], s52 offen offset:3072 sc1 lds
s_waitcnt vmcnt(5)
s_barrier
ds_read_b64_tr_b16 a[0:1], v242 offset:0
ds_read_b64_tr_b16 a[2:3], v242 offset:4096
ds_read_b64_tr_b16 a[4:5], v243 offset:0
ds_read_b64_tr_b16 a[6:7], v243 offset:4096
ds_read_b64_tr_b16 a[8:9], v242 offset:8192
ds_read_b64_tr_b16 a[10:11], v242 offset:12288
ds_read_b64_tr_b16 a[12:13], v243 offset:8192
ds_read_b64_tr_b16 a[14:15], v243 offset:12288
s_add_u32 m0, s71, 4608
s_nop 0
buffer_load_dwordx4 v4, s[36:39], s82 offen offset:0 sc1 lds
ds_read_b64_tr_b16 a[16:17], v9 offset:0
ds_read_b64_tr_b16 a[18:19], v9 offset:4096
ds_read_b64_tr_b16 a[20:21], v10 offset:0
ds_read_b64_tr_b16 a[22:23], v10 offset:4096
ds_read_b64_tr_b16 a[24:25], v9 offset:8192
ds_read_b64_tr_b16 a[26:27], v9 offset:12288
ds_read_b64_tr_b16 a[28:29], v10 offset:8192
ds_read_b64_tr_b16 a[30:31], v10 offset:12288
ds_read_b128 v[200:203], v224 offset:8192
ds_read_b128 v[204:207], v224 offset:9216
v_mfma_f32_16x16x32_bf16 v[168:171], a[252:255], v[216:219], v[168:171]
s_waitcnt lgkmcnt(15)
v_mfma_f32_16x16x32_bf16 v[164:167], v[116:119], v[220:223], v[164:167]
ds_read_b128 v[208:211], v224 offset:10240
ds_read_b128 v[212:215], v224 offset:11264
v_mfma_f32_16x16x32_bf16 v[168:171], v[120:123], v[220:223], v[168:171]
buffer_load_dwordx4 v4, s[36:39], s82 offen offset:1024 sc1 lds
v_mfma_f32_16x16x32_bf16 v[164:167], v[124:127], v[192:195], v[164:167]
ds_read_b128 v[216:219], v224 offset:26624
v_mfma_f32_16x16x32_bf16 v[168:171], v[128:131], v[192:195], v[168:171]
v_mfma_f32_16x16x32_bf16 v[164:167], v[132:135], v[196:199], v[164:167]
s_add_u32 m0, s60, 114688
ds_read_b128 v[220:223], v224 offset:27648
v_mfma_f32_16x16x32_bf16 v[168:171], v[136:139], v[196:199], v[168:171]
s_waitcnt lgkmcnt(5)
buffer_load_dwordx4 v7, s[32:35], s73 offen lds
v_mfma_f32_16x16x32_bf16 v[156:159], a[0:3], v[200:203], v[156:159]
ds_read_b128 v[192:195], v224 offset:28672
v_mfma_f32_16x16x32_bf16 v[160:163], a[4:7], v[200:203], v[160:163]
s_waitcnt lgkmcnt(5)
v_mfma_f32_16x16x32_bf16 v[156:159], a[8:11], v[204:207], v[156:159]
ds_read_b128 v[196:199], v224 offset:29696
v_mfma_f32_16x16x32_bf16 v[160:163], a[12:15], v[204:207], v[160:163]
s_waitcnt lgkmcnt(5)
v_mfma_f32_16x16x32_bf16 v[156:159], a[16:19], v[208:211], v[156:159]
s_mov_b32 s74, 479232
v_mfma_f32_16x16x32_bf16 v[160:163], a[20:23], v[208:211], v[160:163]
s_waitcnt lgkmcnt(4)
buffer_load_dwordx4 v8, s[32:35], s73 offen offset:1024 lds
v_mfma_f32_16x16x32_bf16 v[156:159], a[24:27], v[212:215], v[156:159]
v_mfma_f32_16x16x32_bf16 v[160:163], a[28:31], v[212:215], v[160:163]
s_waitcnt lgkmcnt(3)
v_mfma_f32_16x16x32_bf16 v[164:167], a[0:3], v[216:219], v[164:167]
s_add_u32 m0, s60, 122880
s_nop 0
buffer_load_dwordx4 v7, s[32:35], s74 offen lds
s_waitcnt vmcnt(5)
s_barrier
ds_read_b128 v[200:203], v12 offset:0
ds_read_b128 v[204:207], v12 offset:1024
v_mfma_f32_16x16x32_bf16 v[168:171], a[4:7], v[216:219], v[168:171]
s_waitcnt lgkmcnt(4)
v_mfma_f32_16x16x32_bf16 v[164:167], a[8:11], v[220:223], v[164:167]
s_mov_b32 s73, 516096
ds_read_b128 v[208:211], v12 offset:2048
ds_read_b128 v[212:215], v12 offset:3072
v_mfma_f32_16x16x32_bf16 v[168:171], a[12:15], v[220:223], v[168:171]
s_waitcnt lgkmcnt(5)
buffer_load_dwordx4 v8, s[32:35], s74 offen offset:1024 lds
v_mfma_f32_16x16x32_bf16 v[164:167], a[16:19], v[192:195], v[164:167]
ds_read_b128 v[216:219], v12 offset:4096
v_mfma_f32_16x16x32_bf16 v[168:171], a[20:23], v[192:195], v[168:171]
s_waitcnt lgkmcnt(5)
v_mfma_f32_16x16x32_bf16 v[164:167], a[24:27], v[196:199], v[164:167]
buffer_store_dword v14, v230, s[36:39], 0 offen offset:384
ds_read_b128 v[220:223], v12 offset:5120
v_mfma_f32_16x16x32_bf16 v[168:171], a[28:31], v[196:199], v[168:171]
s_waitcnt lgkmcnt(5)
v_mfma_f32_16x16x32_bf16 v[172:175], a[216:219], v[200:203], 0
s_add_u32 m0, s60, 131072
ds_read_b128 v[192:195], v12 offset:6144
v_mfma_f32_16x16x32_bf16 v[176:179], a[220:223], v[200:203], 0
s_waitcnt lgkmcnt(5)
buffer_load_dwordx4 v7, s[32:35], s73 offen lds
v_mfma_f32_16x16x32_bf16 v[172:175], a[224:227], v[204:207], v[172:175]
ds_read_b128 v[196:199], v12 offset:7168
v_mfma_f32_16x16x32_bf16 v[176:179], a[228:231], v[204:207], v[176:179]
s_waitcnt lgkmcnt(5)
v_mfma_f32_16x16x32_bf16 v[172:175], a[232:235], v[208:211], v[172:175]
s_mov_b32 s74, 552960
ds_read_b128 v[200:203], v12 offset:8192
v_mfma_f32_16x16x32_bf16 v[176:179], a[236:239], v[208:211], v[176:179]
s_waitcnt lgkmcnt(5)
buffer_load_dwordx4 v8, s[32:35], s73 offen offset:1024 lds
v_mfma_f32_16x16x32_bf16 v[172:175], a[240:243], v[212:215], v[172:175]
ds_read_b128 v[204:207], v12 offset:9216
v_mfma_f32_16x16x32_bf16 v[176:179], a[244:247], v[212:215], v[176:179]
s_waitcnt lgkmcnt(5)
v_mfma_f32_16x16x32_bf16 v[172:175], a[248:251], v[216:219], v[172:175]
s_add_u32 m0, s60, 139264
ds_read_b128 v[208:211], v12 offset:10240
v_mfma_f32_16x16x32_bf16 v[176:179], a[252:255], v[216:219], v[176:179]
s_waitcnt lgkmcnt(5)
buffer_load_dwordx4 v7, s[32:35], s74 offen lds
v_mfma_f32_16x16x32_bf16 v[172:175], v[116:119], v[220:223], v[172:175]
ds_read_b128 v[212:215], v12 offset:11264
v_mfma_f32_16x16x32_bf16 v[176:179], v[120:123], v[220:223], v[176:179]
s_waitcnt lgkmcnt(5)
v_mfma_f32_16x16x32_bf16 v[172:175], v[124:127], v[192:195], v[172:175]
s_mov_b32 s73, 589824
v_mfma_f32_16x16x32_bf16 v[176:179], v[128:131], v[192:195], v[176:179]
s_waitcnt lgkmcnt(4)
buffer_load_dwordx4 v8, s[32:35], s74 offen offset:1024 lds
v_mfma_f32_16x16x32_bf16 v[172:175], v[132:135], v[196:199], v[172:175]
buffer_load_dword v251, v231, s[36:39], 0 offen offset:384 sc1
v_mfma_f32_16x16x32_bf16 v[176:179], v[136:139], v[196:199], v[176:179]
s_waitcnt lgkmcnt(3)
v_mfma_f32_16x16x32_bf16 v[172:175], a[0:3], v[200:203], v[172:175]
s_add_u32 m0, s60, 147456
s_nop 0
buffer_load_dwordx4 v7, s[32:35], s73 offen lds
s_mov_b32 s74, 626688
s_nop 0
buffer_load_dwordx4 v8, s[32:35], s73 offen offset:1024 lds
s_add_u32 m0, s60, 155648
s_nop 0
buffer_load_dwordx4 v7, s[32:35], s74 offen lds
s_mov_b32 s73, 663552
s_nop 0
buffer_load_dwordx4 v8, s[32:35], s74 offen offset:1024 lds
s_waitcnt vmcnt(4)
v_cmp_ne_u32 vcc, s49, v251
s_cbranch_vccnz L_slow_52
L_bak_53:
s_add_u32 m0, s75, 59904
s_add_u32 s52, s53, 55296
s_nop 0
buffer_load_dwordx4 v4, s[36:39], s52 offen offset:0 sc1 lds
s_barrier
ds_read_b64_tr_b16 a[32:33], v9 offset:16384
ds_read_b64_tr_b16 a[34:35], v9 offset:20480
ds_read_b64_tr_b16 a[36:37], v10 offset:16384
ds_read_b64_tr_b16 a[38:39], v10 offset:20480
ds_read_b64_tr_b16 a[40:41], v9 offset:24576
ds_read_b64_tr_b16 a[42:43], v9 offset:28672
ds_read_b64_tr_b16 a[44:45], v10 offset:24576
ds_read_b64_tr_b16 a[46:47], v10 offset:28672
ds_read_b64_tr_b16 a[48:49], v9 offset:32768
ds_read_b64_tr_b16 a[50:51], v9 offset:36864
buffer_load_dwordx4 v4, s[36:39], s52 offen offset:1024 sc1 lds
ds_read_b64_tr_b16 a[52:53], v10 offset:32768
ds_read_b64_tr_b16 a[54:55], v10 offset:36864
ds_read_b64_tr_b16 a[56:57], v9 offset:40960
ds_read_b64_tr_b16 a[58:59], v9 offset:45056
ds_read_b64_tr_b16 a[60:61], v10 offset:40960
ds_read_b64_tr_b16 a[62:63], v10 offset:45056
ds_read_b128 v[216:219], v224 offset:12288
ds_read_b128 v[220:223], v224 offset:13312
v_mfma_f32_16x16x32_bf16 v[176:179], a[4:7], v[200:203], v[176:179]
s_waitcnt lgkmcnt(15)
v_mfma_f32_16x16x32_bf16 v[172:175], a[8:11], v[204:207], v[172:175]
ds_read_b128 v[192:195], v224 offset:14336
ds_read_b128 v[196:199], v224 offset:15360
v_mfma_f32_16x16x32_bf16 v[176:179], a[12:15], v[204:207], v[176:179]
v_mfma_f32_16x16x32_bf16 v[172:175], a[16:19], v[208:211], v[172:175]
ds_read_b128 v[200:203], v224 offset:30720
v_mfma_f32_16x16x32_bf16 v[176:179], a[20:23], v[208:211], v[176:179]
buffer_load_dwordx4 v4, s[36:39], s52 offen offset:2048 sc1 lds
v_mfma_f32_16x16x32_bf16 v[172:175], a[24:27], v[212:215], v[172:175]
ds_read_b128 v[204:207], v224 offset:31744
v_mfma_f32_16x16x32_bf16 v[176:179], a[28:31], v[212:215], v[176:179]
s_waitcnt lgkmcnt(5)
v_mfma_f32_16x16x32_bf16 v[156:159], a[32:35], v[216:219], v[156:159]
ds_read_b128 v[208:211], v224 offset:32768
v_mfma_f32_16x16x32_bf16 v[160:163], a[36:39], v[216:219], v[160:163]
s_waitcnt lgkmcnt(5)
buffer_load_dwordx4 v4, s[36:39], s52 offen offset:3072 sc1 lds
v_mfma_f32_16x16x32_bf16 v[156:159], a[40:43], v[220:223], v[156:159]
ds_read_b128 v[212:215], v224 offset:33792
v_mfma_f32_16x16x32_bf16 v[160:163], a[44:47], v[220:223], v[160:163]
s_waitcnt lgkmcnt(5)
v_mfma_f32_16x16x32_bf16 v[156:159], a[48:51], v[192:195], v[156:159]
ds_read_b128 v[216:219], v12 offset:12288
s_waitcnt vmcnt(4)
s_barrier
v_mfma_f32_16x16x32_bf16 v[160:163], a[52:55], v[192:195], v[160:163]
s_waitcnt lgkmcnt(5)
ds_read_b64_tr_b16 a[64:65], v9 offset:49152
ds_read_b64_tr_b16 a[66:67], v9 offset:53248
v_mfma_f32_16x16x32_bf16 v[156:159], a[56:59], v[196:199], v[156:159]
s_add_u32 m0, s75, 98304
s_add_u32 s73, s81, s75
ds_read_b128 v[220:223], v12 offset:13312
v_mfma_f32_16x16x32_bf16 v[160:163], a[60:63], v[196:199], v[160:163]
s_waitcnt lgkmcnt(7)
buffer_load_dwordx4 v4, s[36:39], s73 offen offset:0 sc1 lds
v_mfma_f32_16x16x32_bf16 v[164:167], a[32:35], v[200:203], v[164:167]
ds_read_b128 v[192:195], v12 offset:14336
ds_read_b64_tr_b16 a[68:69], v10 offset:49152
v_mfma_f32_16x16x32_bf16 v[168:171], a[36:39], v[200:203], v[168:171]
s_waitcnt lgkmcnt(8)
buffer_load_dwordx4 v4, s[36:39], s73 offen offset:1024 sc1 lds
v_mfma_f32_16x16x32_bf16 v[164:167], a[40:43], v[204:207], v[164:167]
ds_read_b128 v[196:199], v12 offset:15360
ds_read_b64_tr_b16 a[70:71], v10 offset:53248
v_mfma_f32_16x16x32_bf16 v[168:171], a[44:47], v[204:207], v[168:171]
s_waitcnt lgkmcnt(9)
ds_read_b64_tr_b16 a[72:73], v9 offset:57344
ds_read_b64_tr_b16 a[74:75], v9 offset:61440
v_mfma_f32_16x16x32_bf16 v[164:167], a[48:51], v[208:211], v[164:167]
ds_read_b64_tr_b16 a[76:77], v10 offset:57344
ds_read_b64_tr_b16 a[78:79], v10 offset:61440
v_mfma_f32_16x16x32_bf16 v[168:171], a[52:55], v[208:211], v[168:171]
s_waitcnt lgkmcnt(12)
buffer_load_dwordx4 v4, s[36:39], s73 offen offset:2048 sc1 lds
v_mfma_f32_16x16x32_bf16 v[164:167], a[56:59], v[212:215], v[164:167]
v_mfma_f32_16x16x32_bf16 v[168:171], a[60:63], v[212:215], v[168:171]
s_waitcnt lgkmcnt(11)
v_mfma_f32_16x16x32_bf16 v[172:175], a[32:35], v[216:219], v[172:175]
s_barrier
ds_read_b128 v[200:203], v224 offset:16384
ds_read_b128 v[204:207], v224 offset:17408
v_mfma_f32_16x16x32_bf16 v[176:179], a[36:39], v[216:219], v[176:179]
s_waitcnt lgkmcnt(10)
buffer_load_dwordx4 v4, s[36:39], s73 offen offset:3072 sc1 lds
v_mfma_f32_16x16x32_bf16 v[172:175], a[40:43], v[220:223], v[172:175]
ds_read_b128 v[208:211], v224 offset:34816
ds_read_b128 v[212:215], v224 offset:35840
v_mfma_f32_16x16x32_bf16 v[176:179], a[44:47], v[220:223], v[176:179]
s_waitcnt lgkmcnt(11)
v_mfma_f32_16x16x32_bf16 v[172:175], a[48:51], v[192:195], v[172:175]
s_add_u32 m0, s72, 98304
s_add_u32 s73, s81, s72
ds_read_b128 v[216:219], v12 offset:16384
v_mfma_f32_16x16x32_bf16 v[176:179], a[52:55], v[192:195], v[176:179]
s_waitcnt lgkmcnt(10)
buffer_load_dwordx4 v4, s[36:39], s73 offen sc1 lds
v_mfma_f32_16x16x32_bf16 v[172:175], a[56:59], v[196:199], v[172:175]
ds_read_b128 v[220:223], v12 offset:17408
v_mfma_f32_16x16x32_bf16 v[176:179], a[60:63], v[196:199], v[176:179]
s_waitcnt lgkmcnt(5)
v_mfma_f32_16x16x32_bf16 v[156:159], a[64:67], v[200:203], v[156:159]
v_mfma_f32_16x16x32_bf16 v[160:163], a[68:71], v[200:203], v[160:163]
s_waitcnt lgkmcnt(4)
v_mfma_f32_16x16x32_bf16 v[156:159], a[72:75], v[204:207], v[156:159]
v_mfma_f32_16x16x32_bf16 v[160:163], a[76:79], v[204:207], v[160:163]
s_waitcnt lgkmcnt(3)
v_mfma_f32_16x16x32_bf16 v[164:167], a[64:67], v[208:211], v[164:167]
s_waitcnt vmcnt(5)
s_barrier
ds_read_b128 v[192:195], v12 offset:18432
ds_read_b128 v[196:199], v12 offset:19456
v_mfma_f32_16x16x32_bf16 v[168:171], a[68:71], v[208:211], v[168:171]
s_waitcnt lgkmcnt(4)
v_mfma_f32_16x16x32_bf16 v[164:167], a[72:75], v[212:215], v[164:167]
ds_read_b128 v[200:203], v12 offset:20480
ds_read_b128 v[204:207], v12 offset:21504
v_mfma_f32_16x16x32_bf16 v[168:171], a[76:79], v[212:215], v[168:171]
s_waitcnt lgkmcnt(5)
v_cvt_pk_bf16_f32 v52, v156, v157
v_cvt_pk_bf16_f32 v53, v158, v159
v_mfma_f32_16x16x32_bf16 v[172:175], a[64:67], v[216:219], v[172:175]
ds_read_b128 v[208:211], v12 offset:22528
v_cvt_pk_bf16_f32 v54, v160, v161
v_mfma_f32_16x16x32_bf16 v[176:179], a[68:71], v[216:219], v[176:179]
s_waitcnt lgkmcnt(5)
v_cvt_pk_bf16_f32 v55, v162, v163
v_mfma_f32_16x16x32_bf16 v[172:175], a[72:75], v[220:223], v[172:175]
s_mov_b32 s83, 0
buffer_store_dwordx4 v[52:55], v234, s[36:39], s83 offen sc1
ds_read_b128 v[212:215], v12 offset:23552
v_mfma_f32_16x16x32_bf16 v[176:179], a[76:79], v[220:223], v[176:179]
s_waitcnt lgkmcnt(5)
v_cvt_pk_bf16_f32 v56, v164, v165
v_cvt_pk_bf16_f32 v57, v166, v167
v_mfma_f32_16x16x32_bf16 v[180:183], a[216:219], v[192:195], 0
ds_read_b128 v[216:219], v12 offset:24576
v_cvt_pk_bf16_f32 v58, v168, v169
v_mfma_f32_16x16x32_bf16 v[184:187], a[220:223], v[192:195], 0
s_waitcnt lgkmcnt(5)
v_cvt_pk_bf16_f32 v59, v170, v171
v_mfma_f32_16x16x32_bf16 v[180:183], a[224:227], v[196:199], v[180:183]
s_mov_b32 s83, 36864
buffer_store_dwordx4 v[56:59], v234, s[36:39], s83 offen sc1
ds_read_b128 v[220:223], v12 offset:25600
v_mfma_f32_16x16x32_bf16 v[184:187], a[228:231], v[196:199], v[184:187]
s_waitcnt lgkmcnt(5)
v_cvt_pk_bf16_f32 v60, v172, v173
v_cvt_pk_bf16_f32 v61, v174, v175
v_mfma_f32_16x16x32_bf16 v[180:183], a[232:235], v[200:203], v[180:183]
ds_read_b128 v[192:195], v12 offset:26624
v_cvt_pk_bf16_f32 v62, v176, v177
v_mfma_f32_16x16x32_bf16 v[184:187], a[236:239], v[200:203], v[184:187]
s_waitcnt lgkmcnt(5)
v_cvt_pk_bf16_f32 v63, v178, v179
s_waitcnt vmcnt(2)
s_barrier
v_mfma_f32_16x16x32_bf16 v[180:183], a[240:243], v[204:207], v[180:183]
s_mov_b32 s83, 73728
buffer_store_dwordx4 v[60:63], v234, s[36:39], s83 offen sc1
ds_read_b128 v[196:199], v12 offset:27648
ds_read_b64_tr_b16 a[144:145], v15 offset:0
ds_read_b64_tr_b16 a[146:147], v15 offset:512
v_mfma_f32_16x16x32_bf16 v[184:187], a[244:247], v[204:207], v[184:187]
s_waitcnt lgkmcnt(7)
ds_read_b64_tr_b16 a[148:149], v15 offset:1024
ds_read_b64_tr_b16 a[150:151], v15 offset:1536
v_mfma_f32_16x16x32_bf16 v[180:183], a[248:251], v[208:211], v[180:183]
ds_read_b128 v[200:203], v12 offset:28672
ds_read_b64_tr_b16 a[152:153], v15 offset:2048
v_mfma_f32_16x16x32_bf16 v[184:187], a[252:255], v[208:211], v[184:187]
s_waitcnt lgkmcnt(10)
ds_read_b64_tr_b16 a[154:155], v15 offset:2560
ds_read_b64_tr_b16 a[156:157], v15 offset:3072
v_mfma_f32_16x16x32_bf16 v[180:183], v[116:119], v[212:215], v[180:183]
ds_read_b128 v[204:207], v12 offset:29696
ds_read_b64_tr_b16 a[158:159], v15 offset:3584
v_mfma_f32_16x16x32_bf16 v[184:187], v[120:123], v[212:215], v[184:187]
s_waitcnt lgkmcnt(13)
ds_read_b64_tr_b16 a[160:161], v15 offset:4096
ds_read_b64_tr_b16 a[162:163], v15 offset:4608
v_mfma_f32_16x16x32_bf16 v[180:183], v[124:127], v[216:219], v[180:183]
ds_read_b128 v[208:211], v12 offset:30720
ds_read_b64_tr_b16 a[164:165], v15 offset:5120
v_mfma_f32_16x16x32_bf16 v[184:187], v[128:131], v[216:219], v[184:187]
s_waitcnt lgkmcnt(15)
ds_read_b64_tr_b16 a[166:167], v15 offset:5632
ds_read_b64_tr_b16 a[168:169], v15 offset:6144
v_mfma_f32_16x16x32_bf16 v[180:183], v[132:135], v[220:223], v[180:183]
ds_read_b128 v[212:215], v12 offset:31744
ds_read_b64_tr_b16 a[170:171], v15 offset:6656
v_mfma_f32_16x16x32_bf16 v[184:187], v[136:139], v[220:223], v[184:187]
ds_read_b64_tr_b16 a[172:173], v15 offset:7168
ds_read_b64_tr_b16 a[174:175], v15 offset:7680
v_mfma_f32_16x16x32_bf16 v[180:183], a[0:3], v[192:195], v[180:183]
ds_read_b128 v[216:219], v12 offset:32768
ds_read_b64_tr_b16 a[176:177], v15 offset:8192
v_mfma_f32_16x16x32_bf16 v[184:187], a[4:7], v[192:195], v[184:187]
s_waitcnt lgkmcnt(15)
ds_read_b64_tr_b16 a[178:179], v15 offset:8704
ds_read_b64_tr_b16 a[180:181], v15 offset:9216
v_mfma_f32_16x16x32_bf16 v[180:183], a[8:11], v[196:199], v[180:183]
ds_read_b128 v[220:223], v12 offset:33792
ds_read_b64_tr_b16 a[182:183], v15 offset:9728
v_mfma_f32_16x16x32_bf16 v[184:187], a[12:15], v[196:199], v[184:187]
ds_read_b64_tr_b16 a[184:185], v15 offset:10240
ds_read_b64_tr_b16 a[186:187], v15 offset:10752
v_mfma_f32_16x16x32_bf16 v[180:183], a[16:19], v[200:203], v[180:183]
ds_read_b128 v[192:195], v12 offset:34816
ds_read_b64_tr_b16 a[188:189], v15 offset:11264
v_mfma_f32_16x16x32_bf16 v[184:187], a[20:23], v[200:203], v[184:187]
s_waitcnt lgkmcnt(15)
ds_read_b64_tr_b16 a[190:191], v15 offset:11776
ds_read_b64_tr_b16 a[192:193], v15 offset:12288
v_mfma_f32_16x16x32_bf16 v[180:183], a[24:27], v[204:207], v[180:183]
ds_read_b128 v[196:199], v12 offset:35840
ds_read_b64_tr_b16 a[194:195], v15 offset:12800
v_mfma_f32_16x16x32_bf16 v[184:187], a[28:31], v[204:207], v[184:187]
ds_read_b64_tr_b16 a[196:197], v15 offset:13312
ds_read_b64_tr_b16 a[198:199], v15 offset:13824
v_mfma_f32_16x16x32_bf16 v[180:183], a[32:35], v[208:211], v[180:183]
ds_read_b64_tr_b16 a[200:201], v15 offset:14336
ds_read_b64_tr_b16 a[202:203], v15 offset:14848
ds_read_b64_tr_b16 a[204:205], v15 offset:15360
ds_read_b64_tr_b16 a[206:207], v15 offset:15872
ds_read_b64_tr_b16 a[208:209], v15 offset:16384
ds_read_b64_tr_b16 a[210:211], v15 offset:16896
ds_read_b64_tr_b16 a[212:213], v15 offset:17408
ds_read_b64_tr_b16 a[214:215], v15 offset:17920
ds_read_b128 v[200:203], v232 offset:0
buffer_load_dword v248, v237, s[36:39], 0 offen sc1
v_mfma_f32_16x16x32_bf16 v[184:187], a[36:39], v[208:211], v[184:187]
s_waitcnt lgkmcnt(15)
v_mfma_f32_16x16x32_bf16 v[180:183], a[40:43], v[212:215], v[180:183]
ds_read_b128 v[204:207], v232 offset:1024
v_mfma_f32_16x16x32_bf16 v[184:187], a[44:47], v[212:215], v[184:187]
v_mfma_f32_16x16x32_bf16 v[180:183], a[48:51], v[216:219], v[180:183]
ds_read_b128 v[208:211], v232 offset:2048
v_mfma_f32_16x16x32_bf16 v[184:187], a[52:55], v[216:219], v[184:187]
v_mfma_f32_16x16x32_bf16 v[180:183], a[56:59], v[220:223], v[180:183]
ds_read_b128 v[212:215], v232 offset:3072
v_mfma_f32_16x16x32_bf16 v[184:187], a[60:63], v[220:223], v[184:187]
v_mfma_f32_16x16x32_bf16 v[180:183], a[64:67], v[192:195], v[180:183]
ds_read_b128 v[216:219], v232 offset:4096
v_mfma_f32_16x16x32_bf16 v[184:187], a[68:71], v[192:195], v[184:187]
s_waitcnt lgkmcnt(15)
v_mfma_f32_16x16x32_bf16 v[180:183], a[72:75], v[196:199], v[180:183]
ds_read_b128 v[220:223], v232 offset:5120
v_mfma_f32_16x16x32_bf16 v[184:187], a[76:79], v[196:199], v[184:187]
s_waitcnt lgkmcnt(5)
v_mfma_f32_16x16x32_bf16 v[188:191], a[144:147], v[200:203], 0
s_waitcnt lgkmcnt(4)
ds_read_b128 v[192:195], v232 offset:6144
v_mfma_f32_16x16x32_bf16 v[188:191], a[148:151], v[204:207], v[188:191]
s_waitcnt lgkmcnt(4)
ds_read_b128 v[196:199], v232 offset:7168
v_mfma_f32_16x16x32_bf16 v[188:191], a[152:155], v[208:211], v[188:191]
s_waitcnt lgkmcnt(4)
ds_read_b128 v[200:203], v232 offset:8192
v_mfma_f32_16x16x32_bf16 v[188:191], a[156:159], v[212:215], v[188:191]
s_waitcnt lgkmcnt(4)
ds_read_b128 v[204:207], v232 offset:9216
v_cvt_pk_bf16_f32 v64, v180, v181
v_mfma_f32_16x16x32_bf16 v[188:191], a[160:163], v[216:219], v[188:191]
s_waitcnt lgkmcnt(4)
ds_read_b128 v[208:211], v232 offset:10240
v_cvt_pk_bf16_f32 v65, v182, v183
v_mfma_f32_16x16x32_bf16 v[188:191], a[164:167], v[220:223], v[188:191]
s_waitcnt lgkmcnt(4)
ds_read_b128 v[212:215], v232 offset:11264
v_cvt_pk_bf16_f32 v66, v184, v185
v_mfma_f32_16x16x32_bf16 v[188:191], a[168:171], v[192:195], v[188:191]
s_waitcnt lgkmcnt(4)
ds_read_b128 v[216:219], v232 offset:12288
v_cvt_pk_bf16_f32 v67, v186, v187
v_mfma_f32_16x16x32_bf16 v[188:191], a[172:175], v[196:199], v[188:191]
s_waitcnt lgkmcnt(4)
s_mov_b32 s83, 110592
buffer_store_dwordx4 v[64:67], v234, s[36:39], s83 offen sc1
ds_read_b128 v[220:223], v232 offset:13312
v_mfma_f32_16x16x32_bf16 v[188:191], a[176:179], v[200:203], v[188:191]
s_waitcnt lgkmcnt(4)
ds_read_b128 v[192:195], v232 offset:14336
v_mfma_f32_16x16x32_bf16 v[188:191], a[180:183], v[204:207], v[188:191]
s_waitcnt lgkmcnt(4)
ds_read_b128 v[196:199], v232 offset:15360
v_mfma_f32_16x16x32_bf16 v[188:191], a[184:187], v[208:211], v[188:191]
s_waitcnt lgkmcnt(4)
ds_read_b128 v[200:203], v232 offset:16384
v_mfma_f32_16x16x32_bf16 v[188:191], a[188:191], v[212:215], v[188:191]
s_waitcnt lgkmcnt(4)
ds_read_b128 v[204:207], v232 offset:17408
v_mfma_f32_16x16x32_bf16 v[188:191], a[192:195], v[216:219], v[188:191]
s_waitcnt lgkmcnt(4)
v_mfma_f32_16x16x32_bf16 v[188:191], a[196:199], v[220:223], v[188:191]
s_waitcnt lgkmcnt(3)
v_mfma_f32_16x16x32_bf16 v[188:191], a[200:203], v[192:195], v[188:191]
s_waitcnt lgkmcnt(2)
v_mfma_f32_16x16x32_bf16 v[188:191], a[204:207], v[196:199], v[188:191]
s_waitcnt lgkmcnt(1)
v_mfma_f32_16x16x32_bf16 v[188:191], a[208:211], v[200:203], v[188:191]
s_waitcnt lgkmcnt(0)
v_mfma_f32_16x16x32_bf16 v[188:191], a[212:215], v[204:207], v[188:191]
L_stream_done:
s_lshr_b32 s52, s44, 1
s_mul_i32 s66, s52, 36864
s_add_u32 s66, s66, s80
s_lshl_b32 s54, s46, 2
s_add_u32 s54, s54, s52
s_mul_i32 s69, s54, 18432
s_and_b32 s53, s44, 1
s_add_u32 s52, s53, s48
v_cvt_pk_bf16_f32 v68, v188, v189
v_cvt_pk_bf16_f32 v69, v190, v191
buffer_store_dwordx2 v[68:69], v235, s[36:39], 0 offen sc1
s_cmp_ge_u32 s48, 2
s_cselect_b32 s52, s52, 0
s_cmp_ge_u32 s52, 3
s_cbranch_scc1 L_fin
s_waitcnt vmcnt(2)
v_cmp_ne_u32 vcc, s49, v248
s_cbranch_vccnz L_slow_74
L_bak_75:
v_mov_b32 v72, 0x3f80
v_mov_b32 v73, 0x3f800000
s_cmp_eq_u32 s48, 2
s_cbranch_scc1 L_73
s_lshl_b32 s53, s53, 1
s_add_u32 s53, s53, s48
s_lshl_b32 s54, s53, 10
s_add_u32 s66, s66, s54
s_lshl_b32 s53, s53, 6
s_lshl_b32 s54, s47, 8
s_add_u32 s69, s69, s53
s_add_u32 s69, s69, s54
s_mov_b32 s61, 0x40000
L_sum_77:
s_mov_b32 s67, s66
buffer_load_dwordx4 v[192:195], v4, s[36:39], s67 offen sc1
s_add_u32 s67, s67, 4608
buffer_load_dwordx4 v[196:199], v4, s[36:39], s67 offen sc1
s_add_u32 s67, s67, 4608
buffer_load_dwordx4 v[200:203], v4, s[36:39], s67 offen sc1
s_add_u32 s67, s67, 4608
buffer_load_dwordx4 v[204:207], v4, s[36:39], s67 offen sc1
s_add_u32 s67, s67, 4608
buffer_load_dwordx4 v[208:211], v4, s[36:39], s67 offen sc1
s_add_u32 s67, s67, 4608
buffer_load_dwordx4 v[212:215], v4, s[36:39], s67 offen sc1
s_add_u32 s67, s67, 4608
buffer_load_dwordx4 v[216:219], v4, s[36:39], s67 offen sc1
s_add_u32 s67, s67, 4608
buffer_load_dwordx4 v[220:223], v4, s[36:39], s67 offen sc1
s_add_u32 s67, s67, 4608
v_lshlrev_b32 v52, 16, v48
v_and_b32 v53, 0xffff0000, v48
v_lshlrev_b32 v54, 16, v49
v_and_b32 v55, 0xffff0000, v49
v_lshlrev_b32 v56, 16, v50
v_and_b32 v57, 0xffff0000, v50
v_lshlrev_b32 v58, 16, v51
v_and_b32 v59, 0xffff0000, v51
v_mov_b32 v74, 0
s_waitcnt vmcnt(7)
v_dot2_f32_bf16 v52, v192, v72, v52
v_dot2_f32_bf16 v53, v192, v73, v53
v_dot2_f32_bf16 v54, v193, v72, v54
v_dot2_f32_bf16 v55, v193, v73, v55
v_dot2_f32_bf16 v56, v194, v72, v56
v_dot2_f32_bf16 v57, v194, v73, v57
v_dot2_f32_bf16 v58, v195, v72, v58
v_dot2_f32_bf16 v59, v195, v73, v59
v_max3_u32 v74, v192, v193, v74
v_max3_u32 v74, v194, v195, v74
s_waitcnt vmcnt(6)
v_dot2_f32_bf16 v52, v196, v72, v52
v_dot2_f32_bf16 v53, v196, v73, v53
v_dot2_f32_bf16 v54, v197, v72, v54
v_dot2_f32_bf16 v55, v197, v73, v55
v_dot2_f32_bf16 v56, v198, v72, v56
v_dot2_f32_bf16 v57, v198, v73, v57
v_dot2_f32_bf16 v58, v199, v72, v58
v_dot2_f32_bf16 v59, v199, v73, v59
v_max3_u32 v74, v196, v197, v74
v_max3_u32 v74, v198, v199, v74
s_waitcnt vmcnt(5)
v_dot2_f32_bf16 v52, v200, v72, v52
v_dot2_f32_bf16 v53, v200, v73, v53
v_dot2_f32_bf16 v54, v201, v72, v54
v_dot2_f32_bf16 v55, v201, v73, v55
v_dot2_f32_bf16 v56, v202, v72, v56
v_dot2_f32_bf16 v57, v202, v73, v57
v_dot2_f32_bf16 v58, v203, v72, v58
v_dot2_f32_bf16 v59, v203, v73, v59
v_max3_u32 v74, v200, v201, v74
v_max3_u32 v74, v202, v203, v74
s_waitcnt vmcnt(4)
v_dot2_f32_bf16 v52, v204, v72, v52
v_dot2_f32_bf16 v53, v204, v73, v53
v_dot2_f32_bf16 v54, v205, v72, v54
v_dot2_f32_bf16 v55, v205, v73, v55
v_dot2_f32_bf16 v56, v206, v72, v56
v_dot2_f32_bf16 v57, v206, v73, v57
v_dot2_f32_bf16 v58, v207, v72, v58
v_dot2_f32_bf16 v59, v207, v73, v59
v_max3_u32 v74, v204, v205, v74
v_max3_u32 v74, v206, v207, v74
s_waitcnt vmcnt(3)
v_dot2_f32_bf16 v52, v208, v72, v52
v_dot2_f32_bf16 v53, v208, v73, v53
v_dot2_f32_bf16 v54, v209, v72, v54
v_dot2_f32_bf16 v55, v209, v73, v55
v_dot2_f32_bf16 v56, v210, v72, v56
v_dot2_f32_bf16 v57, v210, v73, v57
v_dot2_f32_bf16 v58, v211, v72, v58
v_dot2_f32_bf16 v59, v211, v73, v59
v_max3_u32 v74, v208, v209, v74
v_max3_u32 v74, v210, v211, v74
s_waitcnt vmcnt(2)
v_dot2_f32_bf16 v52, v212, v72, v52
v_dot2_f32_bf16 v53, v212, v73, v53
v_dot2_f32_bf16 v54, v213, v72, v54
v_dot2_f32_bf16 v55, v213, v73, v55
v_dot2_f32_bf16 v56, v214, v72, v56
v_dot2_f32_bf16 v57, v214, v73, v57
v_dot2_f32_bf16 v58, v215, v72, v58
v_dot2_f32_bf16 v59, v215, v73, v59
v_max3_u32 v74, v212, v213, v74
v_max3_u32 v74, v214, v215, v74
s_waitcnt vmcnt(1)
v_dot2_f32_bf16 v52, v216, v72, v52
v_dot2_f32_bf16 v53, v216, v73, v53
v_dot2_f32_bf16 v54, v217, v72, v54
v_dot2_f32_bf16 v55, v217, v73, v55
v_dot2_f32_bf16 v56, v218, v72, v56
v_dot2_f32_bf16 v57, v218, v73, v57
v_dot2_f32_bf16 v58, v219, v72, v58
v_dot2_f32_bf16 v59, v219, v73, v59
v_max3_u32 v74, v216, v217, v74
v_max3_u32 v74, v218, v219, v74
s_waitcnt vmcnt(0)
v_dot2_f32_bf16 v52, v220, v72, v52
v_dot2_f32_bf16 v53, v220, v73, v53
v_dot2_f32_bf16 v54, v221, v72, v54
v_dot2_f32_bf16 v55, v221, v73, v55
v_dot2_f32_bf16 v56, v222, v72, v56
v_dot2_f32_bf16 v57, v222, v73, v57
v_dot2_f32_bf16 v58, v223, v72, v58
v_dot2_f32_bf16 v59, v223, v73, v59
v_max3_u32 v74, v220, v221, v74
v_max3_u32 v74, v222, v223, v74
s_sub_u32 s61, s61, 1
v_cmp_eq_u32 vcc, -1, v74
s_cbranch_scc1 L_sumd_78
s_cbranch_vccnz L_sum_77
L_sumd_78:
v_cvt_pk_bf16_f32 v68, v52, v53
v_cvt_pk_bf16_f32 v69, v54, v55
v_cvt_pk_bf16_f32 v70, v56, v57
v_cvt_pk_bf16_f32 v71, v58, v59
buffer_store_dwordx2 v[68:69], v253, s[40:43], s69 offen
buffer_store_dwordx2 v[70:71], v253, s[40:43], s69 offen offset:32
s_branch L_fin
L_73:
s_add_u32 s66, s66, 4096
s_lshl_b32 s54, s47, 5
s_add_u32 s69, s69, s54
s_add_u32 s69, s69, 1024
s_and_b32 s54, s47, 1
s_cselect_b64 vcc, -1, 0
v_cndmask_b32 v48, v48, v50, vcc
v_cndmask_b32 v49, v49, v51, vcc
s_mov_b32 s61, 0x40000
L_sum_79:
s_mov_b32 s67, s66
buffer_load_dwordx2 v[192:193], v13, s[36:39], s67 offen sc1
s_add_u32 s67, s67, 4608
buffer_load_dwordx2 v[196:197], v13, s[36:39], s67 offen sc1
s_add_u32 s67, s67, 4608
buffer_load_dwordx2 v[200:201], v13, s[36:39], s67 offen sc1
s_add_u32 s67, s67, 4608
buffer_load_dwordx2 v[204:205], v13, s[36:39], s67 offen sc1
s_add_u32 s67, s67, 4608
buffer_load_dwordx2 v[208:209], v13, s[36:39], s67 offen sc1
s_add_u32 s67, s67, 4608
buffer_load_dwordx2 v[212:213], v13, s[36:39], s67 offen sc1
s_add_u32 s67, s67, 4608
buffer_load_dwordx2 v[216:217], v13, s[36:39], s67 offen sc1
s_add_u32 s67, s67, 4608
buffer_load_dwordx2 v[220:221], v13, s[36:39], s67 offen sc1
s_add_u32 s67, s67, 4608
v_lshlrev_b32 v52, 16, v48
v_and_b32 v53, 0xffff0000, v48
v_lshlrev_b32 v54, 16, v49
v_and_b32 v55, 0xffff0000, v49
v_mov_b32 v74, 0
s_waitcnt vmcnt(7)
v_dot2_f32_bf16 v52, v192, v72, v52
v_dot2_f32_bf16 v53, v192, v73, v53
v_dot2_f32_bf16 v54, v193, v72, v54
v_dot2_f32_bf16 v55, v193, v73, v55
v_max3_u32 v74, v192, v193, v74
s_waitcnt vmcnt(6)
v_dot2_f32_bf16 v52, v196, v72, v52
v_dot2_f32_bf16 v53, v196, v73, v53
v_dot2_f32_bf16 v54, v197, v72, v54
v_dot2_f32_bf16 v55, v197, v73, v55
v_max3_u32 v74, v196, v197, v74
s_waitcnt vmcnt(5)
v_dot2_f32_bf16 v52, v200, v72, v52
v_dot2_f32_bf16 v53, v200, v73, v53
v_dot2_f32_bf16 v54, v201, v72, v54
v_dot2_f32_bf16 v55, v201, v73, v55
v_max3_u32 v74, v200, v201, v74
s_waitcnt vmcnt(4)
v_dot2_f32_bf16 v52, v204, v72, v52
v_dot2_f32_bf16 v53, v204, v73, v53
v_dot2_f32_bf16 v54, v205, v72, v54
v_dot2_f32_bf16 v55, v205, v73, v55
v_max3_u32 v74, v204, v205, v74
s_waitcnt vmcnt(3)
v_dot2_f32_bf16 v52, v208, v72, v52
v_dot2_f32_bf16 v53, v208, v73, v53
v_dot2_f32_bf16 v54, v209, v72, v54
v_dot2_f32_bf16 v55, v209, v73, v55
v_max3_u32 v74, v208, v209, v74
s_waitcnt vmcnt(2)
v_dot2_f32_bf16 v52, v212, v72, v52
v_dot2_f32_bf16 v53, v212, v73, v53
v_dot2_f32_bf16 v54, v213, v72, v54
v_dot2_f32_bf16 v55, v213, v73, v55
v_max3_u32 v74, v212, v213, v74
s_waitcnt vmcnt(1)
v_dot2_f32_bf16 v52, v216, v72, v52
v_dot2_f32_bf16 v53, v216, v73, v53
v_dot2_f32_bf16 v54, v217, v72, v54
v_dot2_f32_bf16 v55, v217, v73, v55
v_max3_u32 v74, v216, v217, v74
s_waitcnt vmcnt(0)
v_dot2_f32_bf16 v52, v220, v72, v52
v_dot2_f32_bf16 v53, v220, v73, v53
v_dot2_f32_bf16 v54, v221, v72, v54
v_dot2_f32_bf16 v55, v221, v73, v55
v_max3_u32 v74, v220, v221, v74
s_sub_u32 s61, s61, 1
v_cmp_eq_u32 vcc, -1, v74
s_cbranch_scc1 L_sumd_80
s_cbranch_vccnz L_sum_79
L_sumd_80:
v_cvt_pk_bf16_f32 v68, v52, v53
v_cvt_pk_bf16_f32 v69, v54, v55
buffer_store_dwordx2 v[68:69], v253, s[40:43], s69 offen
L_fin:
L_end:
s_endpgm
L_cold:
L_stream_remote:
s_waitcnt vmcnt(4)
s_barrier
ds_read_b128 v[192:195], v224 offset:0
ds_read_b128 v[196:199], v224 offset:1024
ds_read_b128 v[200:203], v224 offset:2048
ds_read_b128 v[204:207], v224 offset:3072
ds_read_b128 v[208:211], v224 offset:4096
ds_read_b128 v[212:215], v224 offset:5120
s_waitcnt lgkmcnt(5)
v_mfma_f32_16x16x32_bf16 v[80:83], a[0:3], v[192:195], 0
ds_read_b128 v[216:219], v224 offset:6144
v_mov_b32 v40, v32
v_mfma_f32_16x16x32_bf16 v[84:87], a[4:7], v[192:195], 0
s_waitcnt lgkmcnt(5)
v_mov_b32 v41, v33
v_mov_b32 v42, v34
v_mfma_f32_16x16x32_bf16 v[80:83], a[8:11], v[196:199], v[80:83]
s_add_u32 m0, s75, 40960
s_add_u32 s58, s67, 40960
ds_read_b128 v[220:223], v224 offset:7168
v_mfma_f32_16x16x32_bf16 v[84:87], a[12:15], v[196:199], v[84:87]
s_waitcnt lgkmcnt(5)
buffer_load_dwordx4 v4, s[36:39], s58 offen offset:0 sc1 lds
v_mfma_f32_16x16x32_bf16 v[80:83], a[16:19], v[200:203], v[80:83]
ds_read_b128 v[192:195], v224 offset:8192
v_mov_b32 v43, v35
v_mfma_f32_16x16x32_bf16 v[84:87], a[20:23], v[200:203], v[84:87]
s_waitcnt lgkmcnt(5)
v_permlane32_swap_b32 v32, v40
v_permlane32_swap_b32 v33, v41
v_mfma_f32_16x16x32_bf16 v[80:83], a[24:27], v[204:207], v[80:83]
ds_read_b128 v[196:199], v224 offset:9216
v_permlane32_swap_b32 v34, v42
v_mfma_f32_16x16x32_bf16 v[84:87], a[28:31], v[204:207], v[84:87]
s_waitcnt lgkmcnt(5)
v_permlane32_swap_b32 v35, v43
v_mov_b32 v36, v32
v_mfma_f32_16x16x32_bf16 v[80:83], a[32:35], v[208:211], v[80:83]
ds_read_b128 v[200:203], v224 offset:10240
v_mov_b32 v37, v33
v_mfma_f32_16x16x32_bf16 v[84:87], a[36:39], v[208:211], v[84:87]
s_waitcnt lgkmcnt(5)
buffer_load_dwordx4 v4, s[36:39], s58 offen offset:1024 sc1 lds
v_mfma_f32_16x16x32_bf16 v[80:83], a[40:43], v[212:215], v[80:83]
ds_read_b128 v[204:207], v224 offset:11264
v_mov_b32 v38, v34
v_mfma_f32_16x16x32_bf16 v[84:87], a[44:47], v[212:215], v[84:87]
s_waitcnt lgkmcnt(5)
v_mov_b32 v39, v35
v_mov_b32 v44, v40
v_mfma_f32_16x16x32_bf16 v[80:83], a[48:51], v[216:219], v[80:83]
ds_read_b128 v[208:211], v224 offset:12288
v_mov_b32 v45, v41
v_mfma_f32_16x16x32_bf16 v[84:87], a[52:55], v[216:219], v[84:87]
s_waitcnt lgkmcnt(5)
v_mov_b32 v46, v42
v_mov_b32 v47, v43
v_mfma_f32_16x16x32_bf16 v[80:83], a[56:59], v[220:223], v[80:83]
ds_read_b128 v[212:215], v224 offset:13312
v_permlane16_swap_b32 v32, v36
v_mfma_f32_16x16x32_bf16 v[84:87], a[60:63], v[220:223], v[84:87]
s_waitcnt lgkmcnt(5)
buffer_load_dwordx4 v4, s[36:39], s58 offen offset:2048 sc1 lds
v_mfma_f32_16x16x32_bf16 v[80:83], a[64:67], v[192:195], v[80:83]
ds_read_b128 v[216:219], v224 offset:14336
v_permlane16_swap_b32 v33, v37
v_mfma_f32_16x16x32_bf16 v[84:87], a[68:71], v[192:195], v[84:87]
s_waitcnt lgkmcnt(5)
v_permlane16_swap_b32 v34, v38
v_permlane16_swap_b32 v35, v39
v_mfma_f32_16x16x32_bf16 v[80:83], a[72:75], v[196:199], v[80:83]
ds_read_b128 v[220:223], v224 offset:15360
v_permlane16_swap_b32 v40, v44
v_mfma_f32_16x16x32_bf16 v[84:87], a[76:79], v[196:199], v[84:87]
s_waitcnt lgkmcnt(5)
v_permlane16_swap_b32 v41, v45
v_permlane16_swap_b32 v42, v46
v_mfma_f32_16x16x32_bf16 v[80:83], a[80:83], v[200:203], v[80:83]
ds_read_b128 v[192:195], v224 offset:16384
v_permlane16_swap_b32 v43, v47
v_mfma_f32_16x16x32_bf16 v[84:87], a[84:87], v[200:203], v[84:87]
s_waitcnt lgkmcnt(5)
buffer_load_dwordx4 v4, s[36:39], s58 offen offset:3072 sc1 lds
v_mfma_f32_16x16x32_bf16 v[80:83], a[88:91], v[204:207], v[80:83]
ds_read_b128 v[196:199], v224 offset:17408
v_mfma_f32_16x16x32_bf16 v[84:87], a[92:95], v[204:207], v[84:87]
s_waitcnt lgkmcnt(5)
v_mfma_f32_16x16x32_bf16 v[80:83], a[96:99], v[208:211], v[80:83]
ds_read_b128 v[200:203], v224 offset:18432
v_mfma_f32_16x16x32_bf16 v[84:87], a[100:103], v[208:211], v[84:87]
s_waitcnt lgkmcnt(5)
v_mfma_f32_16x16x32_bf16 v[80:83], a[104:107], v[212:215], v[80:83]
s_add_u32 m0, s75, 57344
s_add_u32 s58, s67, 57344
s_waitcnt vmcnt(4)
s_barrier
ds_read_b128 v[204:207], v224 offset:19456
v_mfma_f32_16x16x32_bf16 v[84:87], a[108:111], v[212:215], v[84:87]
s_waitcnt lgkmcnt(5)
buffer_load_dwordx4 v4, s[36:39], s58 offen offset:0 sc1 lds
v_mfma_f32_16x16x32_bf16 v[80:83], a[112:115], v[216:219], v[80:83]
ds_read_b128 v[208:211], v224 offset:20480
v_mfma_f32_16x16x32_bf16 v[84:87], a[116:119], v[216:219], v[84:87]
s_waitcnt lgkmcnt(5)
v_mfma_f32_16x16x32_bf16 v[80:83], a[120:123], v[220:223], v[80:83]
ds_read_b128 v[212:215], v224 offset:21504
v_mfma_f32_16x16x32_bf16 v[84:87], a[124:127], v[220:223], v[84:87]
s_waitcnt lgkmcnt(5)
v_mfma_f32_16x16x32_bf16 v[80:83], a[128:131], v[192:195], v[80:83]
ds_read_b128 v[216:219], v224 offset:22528
v_mfma_f32_16x16x32_bf16 v[84:87], a[132:135], v[192:195], v[84:87]
s_waitcnt lgkmcnt(5)
buffer_load_dwordx4 v4, s[36:39], s58 offen offset:1024 sc1 lds
v_mfma_f32_16x16x32_bf16 v[80:83], a[136:139], v[196:199], v[80:83]
ds_read_b128 v[220:223], v224 offset:23552
v_mfma_f32_16x16x32_bf16 v[84:87], a[140:143], v[196:199], v[84:87]
s_waitcnt lgkmcnt(5)
v_mfma_f32_16x16x32_bf16 v[88:91], a[0:3], v[200:203], 0
ds_read_b128 v[192:195], v224 offset:24576
v_mfma_f32_16x16x32_bf16 v[92:95], a[4:7], v[200:203], 0
s_waitcnt lgkmcnt(5)
v_mfma_f32_16x16x32_bf16 v[88:91], a[8:11], v[204:207], v[88:91]
ds_read_b128 v[196:199], v224 offset:25600
v_mfma_f32_16x16x32_bf16 v[92:95], a[12:15], v[204:207], v[92:95]
s_waitcnt lgkmcnt(5)
buffer_load_dwordx4 v4, s[36:39], s58 offen offset:2048 sc1 lds
v_pk_fma_f32 v[52:53], v[32:33], v[20:21], v[80:81] op_sel_hi:[0,1,1]
v_pk_fma_f32 v[54:55], v[32:33], v[22:23], v[82:83] op_sel_hi:[0,1,1]
v_pk_fma_f32 v[56:57], v[32:33], v[24:25], v[84:85] op_sel_hi:[0,1,1]
v_pk_fma_f32 v[58:59], v[32:33], v[26:27], v[86:87] op_sel_hi:[0,1,1]
v_pk_mul_f32 v[60:61], v[52:53], v[52:53]
v_pk_mul_f32 v[62:63], v[54:55], v[54:55]
v_pk_mul_f32 v[64:65], v[56:57], v[56:57]
v_pk_mul_f32 v[66:67], v[58:59], v[58:59]
v_pk_fma_f32 v[60:61], v[60:61], v[34:35], v[32:33] op_sel:[0,0,1] op_sel_hi:[1,0,1]
v_pk_fma_f32 v[62:63], v[62:63], v[34:35], v[32:33] op_sel:[0,0,1] op_sel_hi:[1,0,1]
v_pk_fma_f32 v[64:65], v[64:65], v[34:35], v[32:33] op_sel:[0,0,1] op_sel_hi:[1,0,1]
v_pk_fma_f32 v[66:67], v[66:67], v[34:35], v[32:33] op_sel:[0,0,1] op_sel_hi:[1,0,1]
v_pk_mul_f32 v[60:61], v[60:61], v[52:53]
v_pk_mul_f32 v[62:63], v[62:63], v[54:55]
v_pk_mul_f32 v[64:65], v[64:65], v[56:57]
v_pk_mul_f32 v[66:67], v[66:67], v[58:59]
v_mfma_f32_16x16x32_bf16 v[88:91], a[16:19], v[208:211], v[88:91]
ds_read_b128 v[200:203], v224 offset:26624
v_exp_f32 v60, v60
v_mfma_f32_16x16x32_bf16 v[92:95], a[20:23], v[208:211], v[92:95]
s_waitcnt lgkmcnt(5)
buffer_load_dwordx4 v4, s[36:39], s58 offen offset:3072 sc1 lds
v_mfma_f32_16x16x32_bf16 v[88:91], a[24:27], v[212:215], v[88:91]
ds_read_b128 v[204:207], v224 offset:27648
v_exp_f32 v61, v61
v_mfma_f32_16x16x32_bf16 v[92:95], a[28:31], v[212:215], v[92:95]
s_waitcnt lgkmcnt(5)
v_exp_f32 v62, v62
v_mfma_f32_16x16x32_bf16 v[88:91], a[32:35], v[216:219], v[88:91]
s_add_u32 m0, s60, 73728
s_add_u32 s58, s66, 73728
ds_read_b128 v[208:211], v224 offset:28672
v_mfma_f32_16x16x32_bf16 v[92:95], a[36:39], v[216:219], v[92:95]
s_waitcnt lgkmcnt(5)
buffer_load_dwordx4 v4, s[36:39], s58 offen offset:0 sc1 lds
v_mfma_f32_16x16x32_bf16 v[88:91], a[40:43], v[220:223], v[88:91]
ds_read_b128 v[212:215], v224 offset:29696
v_exp_f32 v63, v63
v_mfma_f32_16x16x32_bf16 v[92:95], a[44:47], v[220:223], v[92:95]
s_waitcnt lgkmcnt(5)
v_exp_f32 v64, v64
v_mfma_f32_16x16x32_bf16 v[88:91], a[48:51], v[192:195], v[88:91]
ds_read_b128 v[216:219], v224 offset:30720
v_exp_f32 v65, v65
v_mfma_f32_16x16x32_bf16 v[92:95], a[52:55], v[192:195], v[92:95]
s_waitcnt lgkmcnt(5)
v_exp_f32 v66, v66
v_exp_f32 v67, v67
v_pk_fma_f32 v[60:61], v[60:61], v[34:35], v[34:35] op_sel:[0,1,1] op_sel_hi:[1,1,1]
v_pk_fma_f32 v[62:63], v[62:63], v[34:35], v[34:35] op_sel:[0,1,1] op_sel_hi:[1,1,1]
v_pk_fma_f32 v[64:65], v[64:65], v[34:35], v[34:35] op_sel:[0,1,1] op_sel_hi:[1,1,1]
v_pk_fma_f32 v[66:67], v[66:67], v[34:35], v[34:35] op_sel:[0,1,1] op_sel_hi:[1,1,1]
v_mfma_f32_16x16x32_bf16 v[88:91], a[56:59], v[196:199], v[88:91]
ds_read_b128 v[220:223], v224 offset:31744
v_rcp_f32 v60, v60
v_mfma_f32_16x16x32_bf16 v[92:95], a[60:63], v[196:199], v[92:95]
s_waitcnt lgkmcnt(5)
buffer_load_dwordx4 v4, s[36:39], s58 offen offset:1024 sc1 lds
v_mfma_f32_16x16x32_bf16 v[88:91], a[64:67], v[200:203], v[88:91]
ds_read_b128 v[192:195], v224 offset:32768
v_rcp_f32 v61, v61
v_mfma_f32_16x16x32_bf16 v[92:95], a[68:71], v[200:203], v[92:95]
s_waitcnt lgkmcnt(5)
v_rcp_f32 v62, v62
v_mfma_f32_16x16x32_bf16 v[88:91], a[72:75], v[204:207], v[88:91]
ds_read_b128 v[196:199], v224 offset:33792
v_rcp_f32 v63, v63
v_mfma_f32_16x16x32_bf16 v[92:95], a[76:79], v[204:207], v[92:95]
s_waitcnt lgkmcnt(5)
buffer_store_dword v14, v236, s[36:39], 0 offen sc1
v_mfma_f32_16x16x32_bf16 v[88:91], a[80:83], v[208:211], v[88:91]
ds_read_b128 v[200:203], v224 offset:34816
v_rcp_f32 v64, v64
v_mfma_f32_16x16x32_bf16 v[92:95], a[84:87], v[208:211], v[92:95]
s_waitcnt lgkmcnt(5)
buffer_load_dword v252, v241, s[36:39], s68 offen
v_mfma_f32_16x16x32_bf16 v[88:91], a[88:91], v[212:215], v[88:91]
s_waitcnt vmcnt(8)
s_barrier
ds_read_b128 v[204:207], v224 offset:35840
v_mfma_f32_16x16x32_bf16 v[92:95], a[92:95], v[212:215], v[92:95]
s_waitcnt lgkmcnt(5)
v_rcp_f32 v65, v65
v_mfma_f32_16x16x32_bf16 v[88:91], a[96:99], v[216:219], v[88:91]
ds_read_b128 v[208:211], v12 offset:0
v_rcp_f32 v66, v66
v_rcp_f32 v67, v67
v_pk_mul_f32 v[52:53], v[52:53], v[60:61]
v_pk_mul_f32 v[54:55], v[54:55], v[62:63]
v_pk_mul_f32 v[56:57], v[56:57], v[64:65]
v_pk_mul_f32 v[58:59], v[58:59], v[66:67]
v_mfma_f32_16x16x32_bf16 v[92:95], a[100:103], v[216:219], v[92:95]
s_waitcnt lgkmcnt(5)
v_cvt_pk_bf16_f32 v68, v52, v53
v_cvt_pk_bf16_f32 v69, v54, v55
v_cvt_pk_bf16_f32 v70, v56, v57
v_mfma_f32_16x16x32_bf16 v[88:91], a[104:107], v[220:223], v[88:91]
ds_read_b128 v[212:215], v12 offset:1024
v_cvt_pk_bf16_f32 v71, v58, v59
v_mfma_f32_16x16x32_bf16 v[92:95], a[108:111], v[220:223], v[92:95]
s_waitcnt lgkmcnt(5)
buffer_store_dwordx4 v[68:71], v228, s[36:39], 0 offen sc1
v_mfma_f32_16x16x32_bf16 v[88:91], a[112:115], v[192:195], v[88:91]
ds_read_b128 v[216:219], v12 offset:2048
v_mfma_f32_16x16x32_bf16 v[92:95], a[116:119], v[192:195], v[92:95]
s_waitcnt lgkmcnt(5)
v_mfma_f32_16x16x32_bf16 v[88:91], a[120:123], v[196:199], v[88:91]
ds_read_b128 v[220:223], v12 offset:3072
v_mfma_f32_16x16x32_bf16 v[92:95], a[124:127], v[196:199], v[92:95]
s_waitcnt lgkmcnt(5)
v_mfma_f32_16x16x32_bf16 v[88:91], a[128:131], v[200:203], v[88:91]
ds_read_b128 v[192:195], v12 offset:4096
v_mfma_f32_16x16x32_bf16 v[92:95], a[132:135], v[200:203], v[92:95]
s_waitcnt lgkmcnt(5)
v_mfma_f32_16x16x32_bf16 v[88:91], a[136:139], v[204:207], v[88:91]
ds_read_b128 v[196:199], v12 offset:5120
v_mfma_f32_16x16x32_bf16 v[92:95], a[140:143], v[204:207], v[92:95]
s_waitcnt lgkmcnt(5)
v_mfma_f32_16x16x32_bf16 v[96:99], a[0:3], v[208:211], 0
ds_read_b128 v[200:203], v12 offset:6144
v_mfma_f32_16x16x32_bf16 v[100:103], a[4:7], v[208:211], 0
s_waitcnt lgkmcnt(5)
v_mfma_f32_16x16x32_bf16 v[96:99], a[8:11], v[212:215], v[96:99]
ds_read_b128 v[204:207], v12 offset:7168
v_mfma_f32_16x16x32_bf16 v[100:103], a[12:15], v[212:215], v[100:103]
s_waitcnt lgkmcnt(5)
v_pk_fma_f32 v[52:53], v[36:37], v[20:21], v[88:89] op_sel_hi:[0,1,1]
v_pk_fma_f32 v[54:55], v[36:37], v[22:23], v[90:91] op_sel_hi:[0,1,1]
v_pk_fma_f32 v[56:57], v[36:37], v[24:25], v[92:93] op_sel_hi:[0,1,1]
v_pk_fma_f32 v[58:59], v[36:37], v[26:27], v[94:95] op_sel_hi:[0,1,1]
v_pk_mul_f32 v[60:61], v[52:53], v[52:53]
v_pk_mul_f32 v[62:63], v[54:55], v[54:55]
v_pk_mul_f32 v[64:65], v[56:57], v[56:57]
v_pk_mul_f32 v[66:67], v[58:59], v[58:59]
v_pk_fma_f32 v[60:61], v[60:61], v[38:39], v[36:37] op_sel:[0,0,1] op_sel_hi:[1,0,1]
v_pk_fma_f32 v[62:63], v[62:63], v[38:39], v[36:37] op_sel:[0,0,1] op_sel_hi:[1,0,1]
v_pk_fma_f32 v[64:65], v[64:65], v[38:39], v[36:37] op_sel:[0,0,1] op_sel_hi:[1,0,1]
v_pk_fma_f32 v[66:67], v[66:67], v[38:39], v[36:37] op_sel:[0,0,1] op_sel_hi:[1,0,1]
v_pk_mul_f32 v[60:61], v[60:61], v[52:53]
v_pk_mul_f32 v[62:63], v[62:63], v[54:55]
v_pk_mul_f32 v[64:65], v[64:65], v[56:57]
v_pk_mul_f32 v[66:67], v[66:67], v[58:59]
v_mfma_f32_16x16x32_bf16 v[96:99], a[16:19], v[216:219], v[96:99]
ds_read_b128 v[208:211], v12 offset:8192
v_mfma_f32_16x16x32_bf16 v[100:103], a[20:23], v[216:219], v[100:103]
s_waitcnt lgkmcnt(5)
v_exp_f32 v60, v60
v_mfma_f32_16x16x32_bf16 v[96:99], a[24:27], v[220:223], v[96:99]
ds_read_b128 v[212:215], v12 offset:9216
v_mfma_f32_16x16x32_bf16 v[100:103], a[28:31], v[220:223], v[100:103]
s_waitcnt lgkmcnt(5)
v_exp_f32 v61, v61
v_mfma_f32_16x16x32_bf16 v[96:99], a[32:35], v[192:195], v[96:99]
ds_read_b128 v[216:219], v12 offset:10240
v_mfma_f32_16x16x32_bf16 v[100:103], a[36:39], v[192:195], v[100:103]
s_waitcnt lgkmcnt(5)
v_exp_f32 v62, v62
v_mfma_f32_16x16x32_bf16 v[96:99], a[40:43], v[196:199], v[96:99]
ds_read_b128 v[220:223], v12 offset:11264
v_mfma_f32_16x16x32_bf16 v[100:103], a[44:47], v[196:199], v[100:103]
s_waitcnt lgkmcnt(5)
v_exp_f32 v63, v63
v_mfma_f32_16x16x32_bf16 v[96:99], a[48:51], v[200:203], v[96:99]
ds_read_b128 v[192:195], v12 offset:12288
v_mfma_f32_16x16x32_bf16 v[100:103], a[52:55], v[200:203], v[100:103]
s_waitcnt lgkmcnt(5)
v_exp_f32 v64, v64
v_mfma_f32_16x16x32_bf16 v[96:99], a[56:59], v[204:207], v[96:99]
ds_read_b128 v[196:199], v12 offset:13312
v_mfma_f32_16x16x32_bf16 v[100:103], a[60:63], v[204:207], v[100:103]
s_waitcnt lgkmcnt(5)
v_exp_f32 v65, v65
v_mfma_f32_16x16x32_bf16 v[96:99], a[64:67], v[208:211], v[96:99]
ds_read_b128 v[200:203], v12 offset:14336
v_exp_f32 v66, v66
v_exp_f32 v67, v67
v_pk_fma_f32 v[60:61], v[60:61], v[38:39], v[38:39] op_sel:[0,1,1] op_sel_hi:[1,1,1]
v_pk_fma_f32 v[62:63], v[62:63], v[38:39], v[38:39] op_sel:[0,1,1] op_sel_hi:[1,1,1]
v_pk_fma_f32 v[64:65], v[64:65], v[38:39], v[38:39] op_sel:[0,1,1] op_sel_hi:[1,1,1]
v_pk_fma_f32 v[66:67], v[66:67], v[38:39], v[38:39] op_sel:[0,1,1] op_sel_hi:[1,1,1]
v_mfma_f32_16x16x32_bf16 v[100:103], a[68:71], v[208:211], v[100:103]
s_waitcnt lgkmcnt(5)
v_rcp_f32 v60, v60
v_mfma_f32_16x16x32_bf16 v[96:99], a[72:75], v[212:215], v[96:99]
s_waitcnt vmcnt(5)
s_barrier
ds_read_b128 v[204:207], v12 offset:15360
v_mfma_f32_16x16x32_bf16 v[100:103], a[76:79], v[212:215], v[100:103]
s_waitcnt lgkmcnt(5)
v_rcp_f32 v61, v61
v_mfma_f32_16x16x32_bf16 v[96:99], a[80:83], v[216:219], v[96:99]
s_waitcnt vmcnt(0)
buffer_store_dword v14, v230, s[36:39], 0 offen offset:0 sc1
ds_read_b128 v[208:211], v12 offset:16384
v_mfma_f32_16x16x32_bf16 v[100:103], a[84:87], v[216:219], v[100:103]
s_waitcnt lgkmcnt(5)
v_rcp_f32 v62, v62
v_mfma_f32_16x16x32_bf16 v[96:99], a[88:91], v[220:223], v[96:99]
ds_read_b128 v[212:215], v12 offset:17408
v_mfma_f32_16x16x32_bf16 v[100:103], a[92:95], v[220:223], v[100:103]
s_waitcnt lgkmcnt(5)
v_rcp_f32 v63, v63
v_mfma_f32_16x16x32_bf16 v[96:99], a[96:99], v[192:195], v[96:99]
s_add_u32 m0, s60, 98304
s_barrier
ds_read_b128 v[48:51], v233
ds_read_b128 v[216:219], v232 offset:0
v_mfma_f32_16x16x32_bf16 v[100:103], a[100:103], v[192:195], v[100:103]
s_waitcnt lgkmcnt(6)
buffer_load_dwordx4 v7, s[32:35], s73 offen lds
v_mfma_f32_16x16x32_bf16 v[96:99], a[104:107], v[196:199], v[96:99]
ds_read_b128 v[220:223], v232 offset:1024
v_mfma_f32_16x16x32_bf16 v[100:103], a[108:111], v[196:199], v[100:103]
s_waitcnt lgkmcnt(6)
v_rcp_f32 v64, v64
v_mfma_f32_16x16x32_bf16 v[96:99], a[112:115], v[200:203], v[96:99]
s_mov_b32 s74, 36864
ds_read_b128 v[192:195], v232 offset:2048
v_mfma_f32_16x16x32_bf16 v[100:103], a[116:119], v[200:203], v[100:103]
s_waitcnt lgkmcnt(6)
buffer_load_dwordx4 v8, s[32:35], s73 offen offset:1024 lds
v_mfma_f32_16x16x32_bf16 v[96:99], a[120:123], v[204:207], v[96:99]
ds_read_b128 v[196:199], v232 offset:3072
v_mfma_f32_16x16x32_bf16 v[100:103], a[124:127], v[204:207], v[100:103]
s_waitcnt lgkmcnt(6)
v_rcp_f32 v65, v65
v_mfma_f32_16x16x32_bf16 v[96:99], a[128:131], v[208:211], v[96:99]
s_add_u32 m0, s60, 106496
ds_read_b128 v[200:203], v232 offset:4096
v_rcp_f32 v66, v66
v_rcp_f32 v67, v67
v_pk_mul_f32 v[52:53], v[52:53], v[60:61]
v_pk_mul_f32 v[54:55], v[54:55], v[62:63]
v_pk_mul_f32 v[56:57], v[56:57], v[64:65]
v_pk_mul_f32 v[58:59], v[58:59], v[66:67]
v_mfma_f32_16x16x32_bf16 v[100:103], a[132:135], v[208:211], v[100:103]
s_waitcnt lgkmcnt(6)
buffer_load_dwordx4 v7, s[32:35], s74 offen lds
buffer_load_dword v248, v231, s[36:39], 0 offen offset:0 sc1
v_mfma_f32_16x16x32_bf16 v[96:99], a[136:139], v[212:215], v[96:99]
s_mov_b32 s73, 73728
ds_read_b128 v[204:207], v232 offset:5120
v_cvt_pk_bf16_f32 v68, v52, v53
v_mfma_f32_16x16x32_bf16 v[100:103], a[140:143], v[212:215], v[100:103]
s_waitcnt lgkmcnt(5)
buffer_load_dwordx4 v8, s[32:35], s74 offen offset:1024 lds
v_mfma_f32_16x16x32_bf16 v[112:115], a[144:147], v[216:219], 0
s_waitcnt lgkmcnt(4)
ds_read_b128 v[208:211], v232 offset:6144
v_cvt_pk_bf16_f32 v69, v54, v55
v_mfma_f32_16x16x32_bf16 v[112:115], a[148:151], v[220:223], v[112:115]
s_waitcnt lgkmcnt(4)
ds_read_b128 v[212:215], v232 offset:7168
v_cvt_pk_bf16_f32 v70, v56, v57
v_cvt_pk_bf16_f32 v71, v58, v59
v_mfma_f32_16x16x32_bf16 v[112:115], a[152:155], v[192:195], v[112:115]
s_add_u32 m0, s60, 114688
s_waitcnt lgkmcnt(4)
buffer_store_dwordx4 v[68:71], v228, s[36:39], s55 offen sc1
ds_read_b128 v[216:219], v232 offset:8192
v_mfma_f32_16x16x32_bf16 v[112:115], a[156:159], v[196:199], v[112:115]
s_waitcnt lgkmcnt(4)
buffer_load_dwordx4 v7, s[32:35], s73 offen lds
ds_read_b128 v[220:223], v232 offset:9216
v_pk_fma_f32 v[52:53], v[40:41], v[20:21], v[96:97] op_sel_hi:[0,1,1]
v_pk_fma_f32 v[54:55], v[40:41], v[22:23], v[98:99] op_sel_hi:[0,1,1]
v_pk_fma_f32 v[56:57], v[40:41], v[24:25], v[100:101] op_sel_hi:[0,1,1]
v_pk_fma_f32 v[58:59], v[40:41], v[26:27], v[102:103] op_sel_hi:[0,1,1]
v_pk_mul_f32 v[60:61], v[52:53], v[52:53]
v_pk_mul_f32 v[62:63], v[54:55], v[54:55]
v_pk_mul_f32 v[64:65], v[56:57], v[56:57]
v_pk_mul_f32 v[66:67], v[58:59], v[58:59]
v_pk_fma_f32 v[60:61], v[60:61], v[42:43], v[40:41] op_sel:[0,0,1] op_sel_hi:[1,0,1]
v_pk_fma_f32 v[62:63], v[62:63], v[42:43], v[40:41] op_sel:[0,0,1] op_sel_hi:[1,0,1]
v_pk_fma_f32 v[64:65], v[64:65], v[42:43], v[40:41] op_sel:[0,0,1] op_sel_hi:[1,0,1]
v_pk_fma_f32 v[66:67], v[66:67], v[42:43], v[40:41] op_sel:[0,0,1] op_sel_hi:[1,0,1]
v_pk_mul_f32 v[60:61], v[60:61], v[52:53]
v_pk_mul_f32 v[62:63], v[62:63], v[54:55]
v_pk_mul_f32 v[64:65], v[64:65], v[56:57]
v_pk_mul_f32 v[66:67], v[66:67], v[58:59]
v_mfma_f32_16x16x32_bf16 v[112:115], a[160:163], v[200:203], v[112:115]
s_mov_b32 s74, 110592
s_waitcnt lgkmcnt(4)
ds_read_b128 v[192:195], v232 offset:10240
v_mfma_f32_16x16x32_bf16 v[112:115], a[164:167], v[204:207], v[112:115]
s_waitcnt lgkmcnt(4)
buffer_load_dwordx4 v8, s[32:35], s73 offen offset:1024 lds
ds_read_b128 v[196:199], v232 offset:11264
v_mfma_f32_16x16x32_bf16 v[112:115], a[168:171], v[208:211], v[112:115]
s_waitcnt lgkmcnt(4)
ds_read_b128 v[200:203], v232 offset:12288
v_mfma_f32_16x16x32_bf16 v[112:115], a[172:175], v[212:215], v[112:115]
s_waitcnt lgkmcnt(4)
ds_read_b128 v[204:207], v232 offset:13312
v_exp_f32 v60, v60
v_mfma_f32_16x16x32_bf16 v[112:115], a[176:179], v[216:219], v[112:115]
s_add_u32 m0, s60, 122880
s_waitcnt lgkmcnt(4)
ds_read_b128 v[208:211], v232 offset:14336
v_mfma_f32_16x16x32_bf16 v[112:115], a[180:183], v[220:223], v[112:115]
s_waitcnt lgkmcnt(4)
buffer_load_dwordx4 v7, s[32:35], s74 offen lds
ds_read_b128 v[212:215], v232 offset:15360
v_mfma_f32_16x16x32_bf16 v[112:115], a[184:187], v[192:195], v[112:115]
s_waitcnt lgkmcnt(4)
ds_read_b128 v[216:219], v232 offset:16384
v_mfma_f32_16x16x32_bf16 v[112:115], a[188:191], v[196:199], v[112:115]
s_waitcnt lgkmcnt(4)
ds_read_b128 v[220:223], v232 offset:17408
v_exp_f32 v61, v61
v_mfma_f32_16x16x32_bf16 v[112:115], a[192:195], v[200:203], v[112:115]
s_mov_b32 s73, 147456
s_waitcnt lgkmcnt(4)
ds_read_b128 v[192:195], v12 offset:18432
v_mfma_f32_16x16x32_bf16 v[112:115], a[196:199], v[204:207], v[112:115]
s_waitcnt lgkmcnt(4)
buffer_load_dwordx4 v8, s[32:35], s74 offen offset:1024 lds
ds_read_b128 v[196:199], v12 offset:19456
v_mfma_f32_16x16x32_bf16 v[112:115], a[200:203], v[208:211], v[112:115]
s_waitcnt lgkmcnt(4)
ds_read_b128 v[200:203], v12 offset:20480
v_mfma_f32_16x16x32_bf16 v[112:115], a[204:207], v[212:215], v[112:115]
s_waitcnt lgkmcnt(4)
ds_read_b128 v[204:207], v12 offset:21504
v_exp_f32 v62, v62
v_mfma_f32_16x16x32_bf16 v[112:115], a[208:211], v[216:219], v[112:115]
s_add_u32 m0, s60, 131072
s_waitcnt lgkmcnt(4)
ds_read_b128 v[208:211], v12 offset:22528
v_mfma_f32_16x16x32_bf16 v[112:115], a[212:215], v[220:223], v[112:115]
s_waitcnt lgkmcnt(4)
buffer_load_dwordx4 v7, s[32:35], s73 offen lds
ds_read_b128 v[212:215], v12 offset:23552
v_mfma_f32_16x16x32_bf16 v[104:107], a[0:3], v[192:195], 0
ds_read_b128 v[216:219], v12 offset:24576
s_waitcnt vmcnt(7)
v_cmp_ne_u32 vcc, s49, v248
v_mfma_f32_16x16x32_bf16 v[108:111], a[4:7], v[192:195], 0
s_waitcnt lgkmcnt(5)
s_cbranch_vccnz L_slow_58
L_bak_59:
s_barrier
v_mfma_f32_16x16x32_bf16 v[104:107], a[8:11], v[196:199], v[104:107]
s_mov_b32 s74, 184320
ds_read_b128 v[220:223], v12 offset:25600
v_mfma_f32_16x16x32_bf16 v[108:111], a[12:15], v[196:199], v[108:111]
s_waitcnt lgkmcnt(5)
buffer_load_dwordx4 v8, s[32:35], s73 offen offset:1024 lds
v_mfma_f32_16x16x32_bf16 v[104:107], a[16:19], v[200:203], v[104:107]
ds_read_b128 v[192:195], v12 offset:26624
v_mfma_f32_16x16x32_bf16 v[108:111], a[20:23], v[200:203], v[108:111]
s_waitcnt lgkmcnt(5)
v_exp_f32 v63, v63
v_mfma_f32_16x16x32_bf16 v[104:107], a[24:27], v[204:207], v[104:107]
s_add_u32 m0, s75, 4608
s_add_u32 s52, s53, 0
ds_read_b128 v[196:199], v12 offset:27648
v_mfma_f32_16x16x32_bf16 v[108:111], a[28:31], v[204:207], v[108:111]
s_waitcnt lgkmcnt(5)
buffer_load_dwordx4 v4, s[36:39], s52 offen offset:0 sc1 lds
v_mfma_f32_16x16x32_bf16 v[104:107], a[32:35], v[208:211], v[104:107]
ds_read_b128 v[200:203], v12 offset:28672
v_mfma_f32_16x16x32_bf16 v[108:111], a[36:39], v[208:211], v[108:111]
s_waitcnt lgkmcnt(5)
v_exp_f32 v64, v64
v_mfma_f32_16x16x32_bf16 v[104:107], a[40:43], v[212:215], v[104:107]
ds_read_b128 v[204:207], v12 offset:29696
v_mfma_f32_16x16x32_bf16 v[108:111], a[44:47], v[212:215], v[108:111]
s_waitcnt lgkmcnt(5)
buffer_load_dwordx4 v4, s[36:39], s52 offen offset:1024 sc1 lds
v_mfma_f32_16x16x32_bf16 v[104:107], a[48:51], v[216:219], v[104:107]
s_waitcnt vmcnt(8)
buffer_store_dword v14, v230, s[36:39], 0 offen offset:128 sc1
ds_read_b128 v[208:211], v12 offset:30720
v_mfma_f32_16x16x32_bf16 v[108:111], a[52:55], v[216:219], v[108:111]
s_waitcnt lgkmcnt(5)
v_exp_f32 v65, v65
v_mfma_f32_16x16x32_bf16 v[104:107], a[56:59], v[220:223], v[104:107]
ds_read_b128 v[212:215], v12 offset:31744
v_exp_f32 v66, v66
v_exp_f32 v67, v67
v_pk_fma_f32 v[60:61], v[60:61], v[42:43], v[42:43] op_sel:[0,1,1] op_sel_hi:[1,1,1]
v_pk_fma_f32 v[62:63], v[62:63], v[42:43], v[42:43] op_sel:[0,1,1] op_sel_hi:[1,1,1]
v_pk_fma_f32 v[64:65], v[64:65], v[42:43], v[42:43] op_sel:[0,1,1] op_sel_hi:[1,1,1]
v_pk_fma_f32 v[66:67], v[66:67], v[42:43], v[42:43] op_sel:[0,1,1] op_sel_hi:[1,1,1]
v_mfma_f32_16x16x32_bf16 v[108:111], a[60:63], v[220:223], v[108:111]
s_waitcnt lgkmcnt(5)
buffer_load_dwordx4 v4, s[36:39], s52 offen offset:2048 sc1 lds
s_waitcnt vmcnt(6)
s_barrier
v_mfma_f32_16x16x32_bf16 v[104:107], a[64:67], v[192:195], v[104:107]
ds_read_b128 v[216:219], v12 offset:32768
ds_read_b64_tr_b16 a[216:217], v9 offset:0
v_mfma_f32_16x16x32_bf16 v[108:111], a[68:71], v[192:195], v[108:111]
s_waitcnt lgkmcnt(6)
buffer_load_dwordx4 v4, s[36:39], s52 offen offset:3072 sc1 lds
ds_read_b64_tr_b16 a[218:219], v9 offset:4096
v_mfma_f32_16x16x32_bf16 v[104:107], a[72:75], v[196:199], v[104:107]
ds_read_b128 v[220:223], v12 offset:33792
ds_read_b64_tr_b16 a[220:221], v10 offset:0
v_mfma_f32_16x16x32_bf16 v[108:111], a[76:79], v[196:199], v[108:111]
s_waitcnt lgkmcnt(8)
ds_read_b64_tr_b16 a[222:223], v10 offset:4096
ds_read_b64_tr_b16 a[224:225], v9 offset:8192
ds_read_b64_tr_b16 a[226:227], v9 offset:12288
v_mfma_f32_16x16x32_bf16 v[104:107], a[80:83], v[200:203], v[104:107]
s_add_u32 m0, s60, 139264
ds_read_b128 v[192:195], v12 offset:34816
ds_read_b64_tr_b16 a[228:229], v10 offset:8192
v_mfma_f32_16x16x32_bf16 v[108:111], a[84:87], v[200:203], v[108:111]
s_waitcnt lgkmcnt(12)
buffer_load_dwordx4 v7, s[32:35], s74 offen lds
ds_read_b64_tr_b16 a[230:231], v10 offset:12288
v_mfma_f32_16x16x32_bf16 v[104:107], a[88:91], v[204:207], v[104:107]
ds_read_b128 v[196:199], v12 offset:35840
ds_read_b64_tr_b16 a[232:233], v9 offset:16384
v_mfma_f32_16x16x32_bf16 v[108:111], a[92:95], v[204:207], v[108:111]
s_waitcnt lgkmcnt(14)
ds_read_b64_tr_b16 a[234:235], v9 offset:20480
ds_read_b64_tr_b16 a[236:237], v10 offset:16384
ds_read_b64_tr_b16 a[238:239], v10 offset:20480
v_mfma_f32_16x16x32_bf16 v[104:107], a[96:99], v[208:211], v[104:107]
s_mov_b32 s73, 221184
buffer_load_dword v249, v231, s[36:39], 0 offen offset:128 sc1
v_mfma_f32_16x16x32_bf16 v[108:111], a[100:103], v[208:211], v[108:111]
s_waitcnt lgkmcnt(15)
buffer_load_dwordx4 v8, s[32:35], s74 offen offset:1024 lds
ds_read_b64_tr_b16 a[240:241], v9 offset:24576
v_mfma_f32_16x16x32_bf16 v[104:107], a[104:107], v[212:215], v[104:107]
ds_read_b64_tr_b16 a[242:243], v9 offset:28672
ds_read_b64_tr_b16 a[244:245], v10 offset:24576
v_mfma_f32_16x16x32_bf16 v[108:111], a[108:111], v[212:215], v[108:111]
ds_read_b64_tr_b16 a[246:247], v10 offset:28672
v_rcp_f32 v60, v60
v_mfma_f32_16x16x32_bf16 v[104:107], a[112:115], v[216:219], v[104:107]
s_add_u32 m0, s60, 147456
s_nop 0
buffer_load_dwordx4 v7, s[32:35], s73 offen lds
v_rcp_f32 v61, v61
v_rcp_f32 v62, v62
v_rcp_f32 v63, v63
v_rcp_f32 v64, v64
v_rcp_f32 v65, v65
v_rcp_f32 v66, v66
v_rcp_f32 v67, v67
v_pk_mul_f32 v[52:53], v[52:53], v[60:61]
v_pk_mul_f32 v[54:55], v[54:55], v[62:63]
v_pk_mul_f32 v[56:57], v[56:57], v[64:65]
v_pk_mul_f32 v[58:59], v[58:59], v[66:67]
s_mov_b32 s74, 258048
s_nop 0
buffer_load_dwordx4 v8, s[32:35], s73 offen offset:1024 lds
v_cvt_pk_bf16_f32 v68, v52, v53
v_cvt_pk_bf16_f32 v69, v54, v55
v_cvt_pk_bf16_f32 v70, v56, v57
v_cvt_pk_bf16_f32 v71, v58, v59
buffer_store_dwordx4 v[68:71], v228, s[36:39], s56 offen sc1
v_pk_fma_f32 v[52:53], v[244:245], v[28:29], v[112:113] op_sel_hi:[0,1,1]
v_pk_fma_f32 v[54:55], v[244:245], v[30:31], v[114:115] op_sel_hi:[0,1,1]
v_pk_mul_f32 v[60:61], v[52:53], v[52:53]
v_pk_mul_f32 v[62:63], v[54:55], v[54:55]
v_pk_fma_f32 v[60:61], v[60:61], v[246:247], v[244:245] op_sel:[0,0,1] op_sel_hi:[1,0,1]
v_pk_fma_f32 v[62:63], v[62:63], v[246:247], v[244:245] op_sel:[0,0,1] op_sel_hi:[1,0,1]
v_pk_mul_f32 v[60:61], v[60:61], v[52:53]
v_pk_mul_f32 v[62:63], v[62:63], v[54:55]
v_exp_f32 v60, v60
v_exp_f32 v61, v61
v_exp_f32 v62, v62
v_exp_f32 v63, v63
v_pk_fma_f32 v[60:61], v[60:61], v[246:247], v[246:247] op_sel:[0,1,1] op_sel_hi:[1,1,1]
v_pk_fma_f32 v[62:63], v[62:63], v[246:247], v[246:247] op_sel:[0,1,1] op_sel_hi:[1,1,1]
v_rcp_f32 v60, v60
s_waitcnt vmcnt(6)
s_barrier
ds_read_b128 v[200:203], v224 offset:0
ds_read_b128 v[204:207], v224 offset:1024
s_add_u32 m0, s60, 155648
v_rcp_f32 v61, v61
v_mfma_f32_16x16x32_bf16 v[108:111], a[116:119], v[216:219], v[108:111]
s_waitcnt lgkmcnt(15)
buffer_load_dwordx4 v7, s[32:35], s74 offen lds
s_waitcnt vmcnt(5)
v_cmp_ne_u32 vcc, s49, v249
v_mfma_f32_16x16x32_bf16 v[104:107], a[120:123], v[220:223], v[104:107]
s_cbranch_vccnz L_slow_61
L_bak_62:
ds_read_b128 v[208:211], v224 offset:2048
ds_read_b128 v[212:215], v224 offset:3072
v_mfma_f32_16x16x32_bf16 v[108:111], a[124:127], v[220:223], v[108:111]
s_waitcnt lgkmcnt(15)
v_rcp_f32 v62, v62
v_rcp_f32 v63, v63
v_pk_mul_f32 v[52:53], v[52:53], v[60:61]
v_pk_mul_f32 v[54:55], v[54:55], v[62:63]
v_mfma_f32_16x16x32_bf16 v[104:107], a[128:131], v[192:195], v[104:107]
s_mov_b32 s73, 294912
v_cvt_pk_bf16_f32 v72, v52, v53
v_cvt_pk_bf16_f32 v73, v54, v55
v_mfma_f32_16x16x32_bf16 v[108:111], a[132:135], v[192:195], v[108:111]
s_waitcnt lgkmcnt(12)
buffer_load_dwordx4 v8, s[32:35], s74 offen offset:1024 lds
buffer_store_dwordx2 v[72:73], v229, s[36:39], 0 offen sc1
v_mfma_f32_16x16x32_bf16 v[104:107], a[136:139], v[196:199], v[104:107]
v_mfma_f32_16x16x32_bf16 v[108:111], a[140:143], v[196:199], v[108:111]
s_waitcnt lgkmcnt(3)
v_mfma_f32_16x16x32_bf16 v[156:159], a[216:219], v[200:203], 0
s_add_u32 m0, s75, 23040
s_add_u32 s52, s53, 18432
s_nop 0
buffer_load_dwordx4 v4, s[36:39], s52 offen offset:0 sc1 lds
buffer_load_dwordx4 v4, s[36:39], s52 offen offset:1024 sc1 lds
buffer_load_dwordx4 v4, s[36:39], s52 offen offset:2048 sc1 lds
buffer_load_dwordx4 v4, s[36:39], s52 offen offset:3072 sc1 lds
s_waitcnt vmcnt(5)
s_barrier
ds_read_b64_tr_b16 a[248:249], v9 offset:32768
ds_read_b64_tr_b16 a[250:251], v9 offset:36864
ds_read_b64_tr_b16 a[252:253], v10 offset:32768
s_add_u32 m0, s60, 81920
s_nop 0
buffer_load_dwordx4 v7, s[32:35], s73 offen lds
buffer_store_dword v14, v230, s[36:39], 0 offen offset:256 sc1
ds_read_b64_tr_b16 a[254:255], v10 offset:36864
ds_read_b64_tr_b16 v[116:117], v9 offset:40960
ds_read_b64_tr_b16 v[118:119], v9 offset:45056
ds_read_b64_tr_b16 v[120:121], v10 offset:40960
ds_read_b64_tr_b16 v[122:123], v10 offset:45056
ds_read_b64_tr_b16 v[124:125], v9 offset:49152
ds_read_b64_tr_b16 v[126:127], v9 offset:53248
ds_read_b64_tr_b16 v[128:129], v10 offset:49152
ds_read_b64_tr_b16 v[130:131], v10 offset:53248
ds_read_b64_tr_b16 v[132:133], v9 offset:57344
ds_read_b64_tr_b16 v[134:135], v9 offset:61440
ds_read_b64_tr_b16 v[136:137], v10 offset:57344
s_mov_b32 s74, 331776
s_nop 0
buffer_load_dwordx4 v8, s[32:35], s73 offen offset:1024 lds
ds_read_b64_tr_b16 v[138:139], v10 offset:61440
ds_read_b128 v[216:219], v224 offset:4096
ds_read_b128 v[220:223], v224 offset:5120
v_mfma_f32_16x16x32_bf16 v[160:163], a[220:223], v[200:203], 0
s_waitcnt lgkmcnt(15)
v_mfma_f32_16x16x32_bf16 v[156:159], a[224:227], v[204:207], v[156:159]
ds_read_b128 v[192:195], v224 offset:6144
ds_read_b128 v[196:199], v224 offset:7168
v_mfma_f32_16x16x32_bf16 v[160:163], a[228:231], v[204:207], v[160:163]
v_pk_fma_f32 v[52:53], v[44:45], v[20:21], v[104:105] op_sel_hi:[0,1,1]
v_pk_fma_f32 v[54:55], v[44:45], v[22:23], v[106:107] op_sel_hi:[0,1,1]
v_pk_fma_f32 v[56:57], v[44:45], v[24:25], v[108:109] op_sel_hi:[0,1,1]
v_pk_fma_f32 v[58:59], v[44:45], v[26:27], v[110:111] op_sel_hi:[0,1,1]
v_pk_mul_f32 v[60:61], v[52:53], v[52:53]
v_pk_mul_f32 v[62:63], v[54:55], v[54:55]
v_pk_mul_f32 v[64:65], v[56:57], v[56:57]
v_pk_mul_f32 v[66:67], v[58:59], v[58:59]
v_pk_fma_f32 v[60:61], v[60:61], v[46:47], v[44:45] op_sel:[0,0,1] op_sel_hi:[1,0,1]
v_pk_fma_f32 v[62:63], v[62:63], v[46:47], v[44:45] op_sel:[0,0,1] op_sel_hi:[1,0,1]
v_pk_fma_f32 v[64:65], v[64:65], v[46:47], v[44:45] op_sel:[0,0,1] op_sel_hi:[1,0,1]
v_pk_fma_f32 v[66:67], v[66:67], v[46:47], v[44:45] op_sel:[0,0,1] op_sel_hi:[1,0,1]
v_pk_mul_f32 v[60:61], v[60:61], v[52:53]
v_pk_mul_f32 v[62:63], v[62:63], v[54:55]
v_pk_mul_f32 v[64:65], v[64:65], v[56:57]
v_pk_mul_f32 v[66:67], v[66:67], v[58:59]
v_mfma_f32_16x16x32_bf16 v[156:159], a[232:235], v[208:211], v[156:159]
s_add_u32 m0, s60, 90112
s_waitcnt vmcnt(7)
buffer_store_dword v14, v230, s[36:39], 0 offen offset:512 sc1
v_mfma_f32_16x16x32_bf16 v[160:163], a[236:239], v[208:211], v[160:163]
buffer_load_dwordx4 v7, s[32:35], s74 offen lds
v_exp_f32 v60, v60
v_mfma_f32_16x16x32_bf16 v[156:159], a[240:243], v[212:215], v[156:159]
s_mov_b32 s73, 368640
buffer_load_dword v250, v231, s[36:39], 0 offen offset:256 sc1
s_waitcnt lgkmcnt(4)
s_barrier
v_mfma_f32_16x16x32_bf16 v[160:163], a[244:247], v[212:215], v[160:163]
s_waitcnt lgkmcnt(3)
buffer_load_dwordx4 v8, s[32:35], s74 offen offset:1024 lds
v_exp_f32 v61, v61
v_mfma_f32_16x16x32_bf16 v[156:159], a[248:251], v[216:219], v[156:159]
s_add_u32 m0, s60, 98304
s_waitcnt vmcnt(7)
s_barrier
ds_read_b128 v[200:203], v224 offset:18432
ds_read_b128 v[204:207], v224 offset:19456
v_mfma_f32_16x16x32_bf16 v[160:163], a[252:255], v[216:219], v[160:163]
s_waitcnt lgkmcnt(4)
buffer_load_dwordx4 v7, s[32:35], s73 offen lds
v_exp_f32 v62, v62
v_mfma_f32_16x16x32_bf16 v[156:159], v[116:119], v[220:223], v[156:159]
s_mov_b32 s74, 405504
ds_read_b128 v[208:211], v224 offset:20480
ds_read_b128 v[212:215], v224 offset:21504
v_exp_f32 v63, v63
v_mfma_f32_16x16x32_bf16 v[160:163], v[120:123], v[220:223], v[160:163]
s_waitcnt lgkmcnt(5)
buffer_load_dwordx4 v8, s[32:35], s73 offen offset:1024 lds
v_exp_f32 v64, v64
v_mfma_f32_16x16x32_bf16 v[156:159], v[124:127], v[192:195], v[156:159]
ds_read_b128 v[216:219], v224 offset:22528
v_exp_f32 v65, v65
v_mfma_f32_16x16x32_bf16 v[160:163], v[128:131], v[192:195], v[160:163]
s_waitcnt lgkmcnt(5)
v_exp_f32 v66, v66
v_exp_f32 v67, v67
v_pk_fma_f32 v[60:61], v[60:61], v[46:47], v[46:47] op_sel:[0,1,1] op_sel_hi:[1,1,1]
v_pk_fma_f32 v[62:63], v[62:63], v[46:47], v[46:47] op_sel:[0,1,1] op_sel_hi:[1,1,1]
v_pk_fma_f32 v[64:65], v[64:65], v[46:47], v[46:47] op_sel:[0,1,1] op_sel_hi:[1,1,1]
v_pk_fma_f32 v[66:67], v[66:67], v[46:47], v[46:47] op_sel:[0,1,1] op_sel_hi:[1,1,1]
v_mfma_f32_16x16x32_bf16 v[156:159], v[132:135], v[196:199], v[156:159]
s_add_u32 m0, s60, 106496
buffer_load_dword v252, v231, s[36:39], 0 offen offset:512 sc1
ds_read_b128 v[220:223], v224 offset:23552
v_mfma_f32_16x16x32_bf16 v[160:163], v[136:139], v[196:199], v[160:163]
s_waitcnt lgkmcnt(5)
buffer_load_dwordx4 v7, s[32:35], s74 offen lds
v_rcp_f32 v60, v60
v_mfma_f32_16x16x32_bf16 v[164:167], a[216:219], v[200:203], 0
s_mov_b32 s73, 442368
ds_read_b128 v[192:195], v224 offset:24576
v_rcp_f32 v61, v61
v_mfma_f32_16x16x32_bf16 v[168:171], a[220:223], v[200:203], 0
s_waitcnt lgkmcnt(5)
buffer_load_dwordx4 v8, s[32:35], s74 offen offset:1024 lds
s_waitcnt vmcnt(6)
v_cmp_ne_u32 vcc, s49, v250
v_mfma_f32_16x16x32_bf16 v[164:167], a[224:227], v[204:207], v[164:167]
s_cbranch_vccnz L_slow_64
L_bak_65:
ds_read_b128 v[196:199], v224 offset:25600
v_mfma_f32_16x16x32_bf16 v[168:171], a[228:231], v[204:207], v[168:171]
s_waitcnt lgkmcnt(5)
v_rcp_f32 v62, v62
v_rcp_f32 v63, v63
v_mfma_f32_16x16x32_bf16 v[164:167], a[232:235], v[208:211], v[164:167]
s_add_u32 m0, s75, 41472
s_add_u32 s52, s53, 36864
v_rcp_f32 v64, v64
v_mfma_f32_16x16x32_bf16 v[168:171], a[236:239], v[208:211], v[168:171]
s_waitcnt lgkmcnt(4)
buffer_load_dwordx4 v4, s[36:39], s52 offen offset:0 sc1 lds
v_rcp_f32 v65, v65
v_mfma_f32_16x16x32_bf16 v[164:167], a[240:243], v[212:215], v[164:167]
v_rcp_f32 v66, v66
v_rcp_f32 v67, v67
v_pk_mul_f32 v[52:53], v[52:53], v[60:61]
v_pk_mul_f32 v[54:55], v[54:55], v[62:63]
v_pk_mul_f32 v[56:57], v[56:57], v[64:65]
v_pk_mul_f32 v[58:59], v[58:59], v[66:67]
v_mfma_f32_16x16x32_bf16 v[168:171], a[244:247], v[212:215], v[168:171]
s_waitcnt lgkmcnt(3)
buffer_load_dwordx4 v4, s[36:39], s52 offen offset:1024 sc1 lds
v_cvt_pk_bf16_f32 v68, v52, v53
v_cvt_pk_bf16_f32 v69, v54, v55
v_mfma_f32_16x16x32_bf16 v[164:167], a[248:251], v[216:219], v[164:167]
v_cvt_pk_bf16_f32 v70, v56, v57
v_cvt_pk_bf16_f32 v71, v58, v59
buffer_load_dwordx4 v4, s[36:39], s52 offen offset:2048 sc1 lds
buffer_store_dwordx4 v[68:71], v228, s[36:39], s57 offen sc1
s_waitcnt vmcnt(6)
v_cmp_ne_u32 vcc, s49, v252
s_cbranch_vccnz L_slow_70
L_bak_71:
buffer_load_dwordx4 v4, s[36:39], s52 offen offset:3072 sc1 lds
s_waitcnt vmcnt(5)
s_barrier
ds_read_b64_tr_b16 a[0:1], v242 offset:0
ds_read_b64_tr_b16 a[2:3], v242 offset:4096
ds_read_b64_tr_b16 a[4:5], v243 offset:0
ds_read_b64_tr_b16 a[6:7], v243 offset:4096
ds_read_b64_tr_b16 a[8:9], v242 offset:8192
ds_read_b64_tr_b16 a[10:11], v242 offset:12288
ds_read_b64_tr_b16 a[12:13], v243 offset:8192
ds_read_b64_tr_b16 a[14:15], v243 offset:12288
s_add_u32 m0, s71, 4608
s_nop 0
buffer_load_dwordx4 v4, s[36:39], s82 offen offset:0 sc1 lds
ds_read_b64_tr_b16 a[16:17], v9 offset:0
ds_read_b64_tr_b16 a[18:19], v9 offset:4096
ds_read_b64_tr_b16 a[20:21], v10 offset:0
ds_read_b64_tr_b16 a[22:23], v10 offset:4096
ds_read_b64_tr_b16 a[24:25], v9 offset:8192
ds_read_b64_tr_b16 a[26:27], v9 offset:12288
ds_read_b64_tr_b16 a[28:29], v10 offset:8192
ds_read_b64_tr_b16 a[30:31], v10 offset:12288
ds_read_b128 v[200:203], v224 offset:8192
ds_read_b128 v[204:207], v224 offset:9216
v_mfma_f32_16x16x32_bf16 v[168:171], a[252:255], v[216:219], v[168:171]
s_waitcnt lgkmcnt(15)
v_mfma_f32_16x16x32_bf16 v[164:167], v[116:119], v[220:223], v[164:167]
ds_read_b128 v[208:211], v224 offset:10240
ds_read_b128 v[212:215], v224 offset:11264
v_mfma_f32_16x16x32_bf16 v[168:171], v[120:123], v[220:223], v[168:171]
buffer_load_dwordx4 v4, s[36:39], s82 offen offset:1024 sc1 lds
v_mfma_f32_16x16x32_bf16 v[164:167], v[124:127], v[192:195], v[164:167]
ds_read_b128 v[216:219], v224 offset:26624
v_mfma_f32_16x16x32_bf16 v[168:171], v[128:131], v[192:195], v[168:171]
v_mfma_f32_16x16x32_bf16 v[164:167], v[132:135], v[196:199], v[164:167]
s_add_u32 m0, s60, 114688
ds_read_b128 v[220:223], v224 offset:27648
v_mfma_f32_16x16x32_bf16 v[168:171], v[136:139], v[196:199], v[168:171]
s_waitcnt lgkmcnt(5)
buffer_load_dwordx4 v7, s[32:35], s73 offen lds
v_mfma_f32_16x16x32_bf16 v[156:159], a[0:3], v[200:203], v[156:159]
ds_read_b128 v[192:195], v224 offset:28672
v_mfma_f32_16x16x32_bf16 v[160:163], a[4:7], v[200:203], v[160:163]
s_waitcnt lgkmcnt(5)
v_mfma_f32_16x16x32_bf16 v[156:159], a[8:11], v[204:207], v[156:159]
ds_read_b128 v[196:199], v224 offset:29696
v_mfma_f32_16x16x32_bf16 v[160:163], a[12:15], v[204:207], v[160:163]
s_waitcnt lgkmcnt(5)
v_mfma_f32_16x16x32_bf16 v[156:159], a[16:19], v[208:211], v[156:159]
s_mov_b32 s74, 479232
v_mfma_f32_16x16x32_bf16 v[160:163], a[20:23], v[208:211], v[160:163]
s_waitcnt lgkmcnt(4)
buffer_load_dwordx4 v8, s[32:35], s73 offen offset:1024 lds
v_mfma_f32_16x16x32_bf16 v[156:159], a[24:27], v[212:215], v[156:159]
v_mfma_f32_16x16x32_bf16 v[160:163], a[28:31], v[212:215], v[160:163]
s_waitcnt lgkmcnt(3)
v_mfma_f32_16x16x32_bf16 v[164:167], a[0:3], v[216:219], v[164:167]
s_add_u32 m0, s60, 122880
s_nop 0
buffer_load_dwordx4 v7, s[32:35], s74 offen lds
s_waitcnt vmcnt(5)
s_barrier
ds_read_b128 v[200:203], v12 offset:0
ds_read_b128 v[204:207], v12 offset:1024
v_mfma_f32_16x16x32_bf16 v[168:171], a[4:7], v[216:219], v[168:171]
s_waitcnt lgkmcnt(4)
v_mfma_f32_16x16x32_bf16 v[164:167], a[8:11], v[220:223], v[164:167]
s_mov_b32 s73, 516096
ds_read_b128 v[208:211], v12 offset:2048
ds_read_b128 v[212:215], v12 offset:3072
v_mfma_f32_16x16x32_bf16 v[168:171], a[12:15], v[220:223], v[168:171]
s_waitcnt lgkmcnt(5)
buffer_load_dwordx4 v8, s[32:35], s74 offen offset:1024 lds
v_mfma_f32_16x16x32_bf16 v[164:167], a[16:19], v[192:195], v[164:167]
ds_read_b128 v[216:219], v12 offset:4096
v_mfma_f32_16x16x32_bf16 v[168:171], a[20:23], v[192:195], v[168:171]
s_waitcnt lgkmcnt(5)
v_mfma_f32_16x16x32_bf16 v[164:167], a[24:27], v[196:199], v[164:167]
buffer_store_dword v14, v230, s[36:39], 0 offen offset:384 sc1
ds_read_b128 v[220:223], v12 offset:5120
v_mfma_f32_16x16x32_bf16 v[168:171], a[28:31], v[196:199], v[168:171]
s_waitcnt lgkmcnt(5)
v_mfma_f32_16x16x32_bf16 v[172:175], a[216:219], v[200:203], 0
s_add_u32 m0, s60, 131072
ds_read_b128 v[192:195], v12 offset:6144
v_mfma_f32_16x16x32_bf16 v[176:179], a[220:223], v[200:203], 0
s_waitcnt lgkmcnt(5)
buffer_load_dwordx4 v7, s[32:35], s73 offen lds
v_mfma_f32_16x16x32_bf16 v[172:175], a[224:227], v[204:207], v[172:175]
ds_read_b128 v[196:199], v12 offset:7168
v_mfma_f32_16x16x32_bf16 v[176:179], a[228:231], v[204:207], v[176:179]
s_waitcnt lgkmcnt(5)
v_mfma_f32_16x16x32_bf16 v[172:175], a[232:235], v[208:211], v[172:175]
s_mov_b32 s74, 552960
ds_read_b128 v[200:203], v12 offset:8192
v_mfma_f32_16x16x32_bf16 v[176:179], a[236:239], v[208:211], v[176:179]
s_waitcnt lgkmcnt(5)
buffer_load_dwordx4 v8, s[32:35], s73 offen offset:1024 lds
v_mfma_f32_16x16x32_bf16 v[172:175], a[240:243], v[212:215], v[172:175]
ds_read_b128 v[204:207], v12 offset:9216
v_mfma_f32_16x16x32_bf16 v[176:179], a[244:247], v[212:215], v[176:179]
s_waitcnt lgkmcnt(5)
v_mfma_f32_16x16x32_bf16 v[172:175], a[248:251], v[216:219], v[172:175]
s_add_u32 m0, s60, 139264
ds_read_b128 v[208:211], v12 offset:10240
v_mfma_f32_16x16x32_bf16 v[176:179], a[252:255], v[216:219], v[176:179]
s_waitcnt lgkmcnt(5)
buffer_load_dwordx4 v7, s[32:35], s74 offen lds
v_mfma_f32_16x16x32_bf16 v[172:175], v[116:119], v[220:223], v[172:175]
ds_read_b128 v[212:215], v12 offset:11264
v_mfma_f32_16x16x32_bf16 v[176:179], v[120:123], v[220:223], v[176:179]
s_waitcnt lgkmcnt(5)
v_mfma_f32_16x16x32_bf16 v[172:175], v[124:127], v[192:195], v[172:175]
s_mov_b32 s73, 589824
v_mfma_f32_16x16x32_bf16 v[176:179], v[128:131], v[192:195], v[176:179]
s_waitcnt lgkmcnt(4)
buffer_load_dwordx4 v8, s[32:35], s74 offen offset:1024 lds
v_mfma_f32_16x16x32_bf16 v[172:175], v[132:135], v[196:199], v[172:175]
buffer_load_dword v251, v231, s[36:39], 0 offen offset:384 sc1
v_mfma_f32_16x16x32_bf16 v[176:179], v[136:139], v[196:199], v[176:179]
s_waitcnt lgkmcnt(3)
v_mfma_f32_16x16x32_bf16 v[172:175], a[0:3], v[200:203], v[172:175]
s_add_u32 m0, s60, 147456
s_nop 0
buffer_load_dwordx4 v7, s[32:35], s73 offen lds
s_mov_b32 s74, 626688
s_nop 0
buffer_load_dwordx4 v8, s[32:35], s73 offen offset:1024 lds
s_add_u32 m0, s60, 155648
s_nop 0
buffer_load_dwordx4 v7, s[32:35], s74 offen lds
s_mov_b32 s73, 663552
s_nop 0
buffer_load_dwordx4 v8, s[32:35], s74 offen offset:1024 lds
s_waitcnt vmcnt(4)
v_cmp_ne_u32 vcc, s49, v251
s_cbranch_vccnz L_slow_67
L_bak_68:
s_add_u32 m0, s75, 59904
s_add_u32 s52, s53, 55296
s_nop 0
buffer_load_dwordx4 v4, s[36:39], s52 offen offset:0 sc1 lds
s_barrier
ds_read_b64_tr_b16 a[32:33], v9 offset:16384
ds_read_b64_tr_b16 a[34:35], v9 offset:20480
ds_read_b64_tr_b16 a[36:37], v10 offset:16384
ds_read_b64_tr_b16 a[38:39], v10 offset:20480
ds_read_b64_tr_b16 a[40:41], v9 offset:24576
ds_read_b64_tr_b16 a[42:43], v9 offset:28672
ds_read_b64_tr_b16 a[44:45], v10 offset:24576
ds_read_b64_tr_b16 a[46:47], v10 offset:28672
ds_read_b64_tr_b16 a[48:49], v9 offset:32768
ds_read_b64_tr_b16 a[50:51], v9 offset:36864
buffer_load_dwordx4 v4, s[36:39], s52 offen offset:1024 sc1 lds
ds_read_b64_tr_b16 a[52:53], v10 offset:32768
ds_read_b64_tr_b16 a[54:55], v10 offset:36864
ds_read_b64_tr_b16 a[56:57], v9 offset:40960
ds_read_b64_tr_b16 a[58:59], v9 offset:45056
ds_read_b64_tr_b16 a[60:61], v10 offset:40960
ds_read_b64_tr_b16 a[62:63], v10 offset:45056
ds_read_b128 v[216:219], v224 offset:12288
ds_read_b128 v[220:223], v224 offset:13312
v_mfma_f32_16x16x32_bf16 v[176:179], a[4:7], v[200:203], v[176:179]
s_waitcnt lgkmcnt(15)
v_mfma_f32_16x16x32_bf16 v[172:175], a[8:11], v[204:207], v[172:175]
ds_read_b128 v[192:195], v224 offset:14336
ds_read_b128 v[196:199], v224 offset:15360
v_mfma_f32_16x16x32_bf16 v[176:179], a[12:15], v[204:207], v[176:179]
v_mfma_f32_16x16x32_bf16 v[172:175], a[16:19], v[208:211], v[172:175]
ds_read_b128 v[200:203], v224 offset:30720
v_mfma_f32_16x16x32_bf16 v[176:179], a[20:23], v[208:211], v[176:179]
buffer_load_dwordx4 v4, s[36:39], s52 offen offset:2048 sc1 lds
v_mfma_f32_16x16x32_bf16 v[172:175], a[24:27], v[212:215], v[172:175]
ds_read_b128 v[204:207], v224 offset:31744
v_mfma_f32_16x16x32_bf16 v[176:179], a[28:31], v[212:215], v[176:179]
s_waitcnt lgkmcnt(5)
v_mfma_f32_16x16x32_bf16 v[156:159], a[32:35], v[216:219], v[156:159]
ds_read_b128 v[208:211], v224 offset:32768
v_mfma_f32_16x16x32_bf16 v[160:163], a[36:39], v[216:219], v[160:163]
s_waitcnt lgkmcnt(5)
buffer_load_dwordx4 v4, s[36:39], s52 offen offset:3072 sc1 lds
v_mfma_f32_16x16x32_bf16 v[156:159], a[40:43], v[220:223], v[156:159]
ds_read_b128 v[212:215], v224 offset:33792
v_mfma_f32_16x16x32_bf16 v[160:163], a[44:47], v[220:223], v[160:163]
s_waitcnt lgkmcnt(5)
v_mfma_f32_16x16x32_bf16 v[156:159], a[48:51], v[192:195], v[156:159]
ds_read_b128 v[216:219], v12 offset:12288
s_waitcnt vmcnt(4)
s_barrier
v_mfma_f32_16x16x32_bf16 v[160:163], a[52:55], v[192:195], v[160:163]
s_waitcnt lgkmcnt(5)
ds_read_b64_tr_b16 a[64:65], v9 offset:49152
ds_read_b64_tr_b16 a[66:67], v9 offset:53248
v_mfma_f32_16x16x32_bf16 v[156:159], a[56:59], v[196:199], v[156:159]
s_add_u32 m0, s75, 98304
s_add_u32 s73, s81, s75
ds_read_b128 v[220:223], v12 offset:13312
v_mfma_f32_16x16x32_bf16 v[160:163], a[60:63], v[196:199], v[160:163]
s_waitcnt lgkmcnt(7)
buffer_load_dwordx4 v4, s[36:39], s73 offen offset:0 sc1 lds
v_mfma_f32_16x16x32_bf16 v[164:167], a[32:35], v[200:203], v[164:167]
ds_read_b128 v[192:195], v12 offset:14336
ds_read_b64_tr_b16 a[68:69], v10 offset:49152
v_mfma_f32_16x16x32_bf16 v[168:171], a[36:39], v[200:203], v[168:171]
s_waitcnt lgkmcnt(8)
buffer_load_dwordx4 v4, s[36:39], s73 offen offset:1024 sc1 lds
v_mfma_f32_16x16x32_bf16 v[164:167], a[40:43], v[204:207], v[164:167]
ds_read_b128 v[196:199], v12 offset:15360
ds_read_b64_tr_b16 a[70:71], v10 offset:53248
v_mfma_f32_16x16x32_bf16 v[168:171], a[44:47], v[204:207], v[168:171]
s_waitcnt lgkmcnt(9)
ds_read_b64_tr_b16 a[72:73], v9 offset:57344
ds_read_b64_tr_b16 a[74:75], v9 offset:61440
v_mfma_f32_16x16x32_bf16 v[164:167], a[48:51], v[208:211], v[164:167]
ds_read_b64_tr_b16 a[76:77], v10 offset:57344
ds_read_b64_tr_b16 a[78:79], v10 offset:61440
v_mfma_f32_16x16x32_bf16 v[168:171], a[52:55], v[208:211], v[168:171]
s_waitcnt lgkmcnt(12)
buffer_load_dwordx4 v4, s[36:39], s73 offen offset:2048 sc1 lds
v_mfma_f32_16x16x32_bf16 v[164:167], a[56:59], v[212:215], v[164:167]
v_mfma_f32_16x16x32_bf16 v[168:171], a[60:63], v[212:215], v[168:171]
s_waitcnt lgkmcnt(11)
v_mfma_f32_16x16x32_bf16 v[172:175], a[32:35], v[216:219], v[172:175]
s_barrier
ds_read_b128 v[200:203], v224 offset:16384
ds_read_b128 v[204:207], v224 offset:17408
v_mfma_f32_16x16x32_bf16 v[176:179], a[36:39], v[216:219], v[176:179]
s_waitcnt lgkmcnt(10)
buffer_load_dwordx4 v4, s[36:39], s73 offen offset:3072 sc1 lds
v_mfma_f32_16x16x32_bf16 v[172:175], a[40:43], v[220:223], v[172:175]
ds_read_b128 v[208:211], v224 offset:34816
ds_read_b128 v[212:215], v224 offset:35840
v_mfma_f32_16x16x32_bf16 v[176:179], a[44:47], v[220:223], v[176:179]
s_waitcnt lgkmcnt(11)
v_mfma_f32_16x16x32_bf16 v[172:175], a[48:51], v[192:195], v[172:175]
s_add_u32 m0, s72, 98304
s_add_u32 s73, s81, s72
ds_read_b128 v[216:219], v12 offset:16384
v_mfma_f32_16x16x32_bf16 v[176:179], a[52:55], v[192:195], v[176:179]
s_waitcnt lgkmcnt(10)
buffer_load_dwordx4 v4, s[36:39], s73 offen sc1 lds
v_mfma_f32_16x16x32_bf16 v[172:175], a[56:59], v[196:199], v[172:175]
ds_read_b128 v[220:223], v12 offset:17408
v_mfma_f32_16x16x32_bf16 v[176:179], a[60:63], v[196:199], v[176:179]
s_waitcnt lgkmcnt(5)
v_mfma_f32_16x16x32_bf16 v[156:159], a[64:67], v[200:203], v[156:159]
v_mfma_f32_16x16x32_bf16 v[160:163], a[68:71], v[200:203], v[160:163]
s_waitcnt lgkmcnt(4)
v_mfma_f32_16x16x32_bf16 v[156:159], a[72:75], v[204:207], v[156:159]
v_mfma_f32_16x16x32_bf16 v[160:163], a[76:79], v[204:207], v[160:163]
s_waitcnt lgkmcnt(3)
v_mfma_f32_16x16x32_bf16 v[164:167], a[64:67], v[208:211], v[164:167]
s_waitcnt vmcnt(5)
s_barrier
ds_read_b128 v[192:195], v12 offset:18432
ds_read_b128 v[196:199], v12 offset:19456
v_mfma_f32_16x16x32_bf16 v[168:171], a[68:71], v[208:211], v[168:171]
s_waitcnt lgkmcnt(4)
v_mfma_f32_16x16x32_bf16 v[164:167], a[72:75], v[212:215], v[164:167]
ds_read_b128 v[200:203], v12 offset:20480
ds_read_b128 v[204:207], v12 offset:21504
v_mfma_f32_16x16x32_bf16 v[168:171], a[76:79], v[212:215], v[168:171]
s_waitcnt lgkmcnt(5)
v_cvt_pk_bf16_f32 v52, v156, v157
v_cvt_pk_bf16_f32 v53, v158, v159
v_mfma_f32_16x16x32_bf16 v[172:175], a[64:67], v[216:219], v[172:175]
ds_read_b128 v[208:211], v12 offset:22528
v_cvt_pk_bf16_f32 v54, v160, v161
v_mfma_f32_16x16x32_bf16 v[176:179], a[68:71], v[216:219], v[176:179]
s_waitcnt lgkmcnt(5)
v_cvt_pk_bf16_f32 v55, v162, v163
v_mfma_f32_16x16x32_bf16 v[172:175], a[72:75], v[220:223], v[172:175]
s_mov_b32 s83, 0
buffer_store_dwordx4 v[52:55], v234, s[36:39], s83 offen sc1
ds_read_b128 v[212:215], v12 offset:23552
v_mfma_f32_16x16x32_bf16 v[176:179], a[76:79], v[220:223], v[176:179]
s_waitcnt lgkmcnt(5)
v_cvt_pk_bf16_f32 v56, v164, v165
v_cvt_pk_bf16_f32 v57, v166, v167
v_mfma_f32_16x16x32_bf16 v[180:183], a[216:219], v[192:195], 0
ds_read_b128 v[216:219], v12 offset:24576
v_cvt_pk_bf16_f32 v58, v168, v169
v_mfma_f32_16x16x32_bf16 v[184:187], a[220:223], v[192:195], 0
s_waitcnt lgkmcnt(5)
v_cvt_pk_bf16_f32 v59, v170, v171
v_mfma_f32_16x16x32_bf16 v[180:183], a[224:227], v[196:199], v[180:183]
s_mov_b32 s83, 36864
buffer_store_dwordx4 v[56:59], v234, s[36:39], s83 offen sc1
ds_read_b128 v[220:223], v12 offset:25600
v_mfma_f32_16x16x32_bf16 v[184:187], a[228:231], v[196:199], v[184:187]
s_waitcnt lgkmcnt(5)
v_cvt_pk_bf16_f32 v60, v172, v173
v_cvt_pk_bf16_f32 v61, v174, v175
v_mfma_f32_16x16x32_bf16 v[180:183], a[232:235], v[200:203], v[180:183]
ds_read_b128 v[192:195], v12 offset:26624
v_cvt_pk_bf16_f32 v62, v176, v177
v_mfma_f32_16x16x32_bf16 v[184:187], a[236:239], v[200:203], v[184:187]
s_waitcnt lgkmcnt(5)
v_cvt_pk_bf16_f32 v63, v178, v179
s_waitcnt vmcnt(2)
s_barrier
v_mfma_f32_16x16x32_bf16 v[180:183], a[240:243], v[204:207], v[180:183]
s_mov_b32 s83, 73728
buffer_store_dwordx4 v[60:63], v234, s[36:39], s83 offen sc1
ds_read_b128 v[196:199], v12 offset:27648
ds_read_b64_tr_b16 a[144:145], v15 offset:0
ds_read_b64_tr_b16 a[146:147], v15 offset:512
v_mfma_f32_16x16x32_bf16 v[184:187], a[244:247], v[204:207], v[184:187]
s_waitcnt lgkmcnt(7)
ds_read_b64_tr_b16 a[148:149], v15 offset:1024
ds_read_b64_tr_b16 a[150:151], v15 offset:1536
v_mfma_f32_16x16x32_bf16 v[180:183], a[248:251], v[208:211], v[180:183]
ds_read_b128 v[200:203], v12 offset:28672
ds_read_b64_tr_b16 a[152:153], v15 offset:2048
v_mfma_f32_16x16x32_bf16 v[184:187], a[252:255], v[208:211], v[184:187]
s_waitcnt lgkmcnt(10)
ds_read_b64_tr_b16 a[154:155], v15 offset:2560
ds_read_b64_tr_b16 a[156:157], v15 offset:3072
v_mfma_f32_16x16x32_bf16 v[180:183], v[116:119], v[212:215], v[180:183]
ds_read_b128 v[204:207], v12 offset:29696
ds_read_b64_tr_b16 a[158:159], v15 offset:3584
v_mfma_f32_16x16x32_bf16 v[184:187], v[120:123], v[212:215], v[184:187]
s_waitcnt lgkmcnt(13)
ds_read_b64_tr_b16 a[160:161], v15 offset:4096
ds_read_b64_tr_b16 a[162:163], v15 offset:4608
v_mfma_f32_16x16x32_bf16 v[180:183], v[124:127], v[216:219], v[180:183]
ds_read_b128 v[208:211], v12 offset:30720
ds_read_b64_tr_b16 a[164:165], v15 offset:5120
v_mfma_f32_16x16x32_bf16 v[184:187], v[128:131], v[216:219], v[184:187]
s_waitcnt lgkmcnt(15)
ds_read_b64_tr_b16 a[166:167], v15 offset:5632
ds_read_b64_tr_b16 a[168:169], v15 offset:6144
v_mfma_f32_16x16x32_bf16 v[180:183], v[132:135], v[220:223], v[180:183]
ds_read_b128 v[212:215], v12 offset:31744
ds_read_b64_tr_b16 a[170:171], v15 offset:6656
v_mfma_f32_16x16x32_bf16 v[184:187], v[136:139], v[220:223], v[184:187]
ds_read_b64_tr_b16 a[172:173], v15 offset:7168
ds_read_b64_tr_b16 a[174:175], v15 offset:7680
v_mfma_f32_16x16x32_bf16 v[180:183], a[0:3], v[192:195], v[180:183]
ds_read_b128 v[216:219], v12 offset:32768
ds_read_b64_tr_b16 a[176:177], v15 offset:8192
v_mfma_f32_16x16x32_bf16 v[184:187], a[4:7], v[192:195], v[184:187]
s_waitcnt lgkmcnt(15)
ds_read_b64_tr_b16 a[178:179], v15 offset:8704
ds_read_b64_tr_b16 a[180:181], v15 offset:9216
v_mfma_f32_16x16x32_bf16 v[180:183], a[8:11], v[196:199], v[180:183]
ds_read_b128 v[220:223], v12 offset:33792
ds_read_b64_tr_b16 a[182:183], v15 offset:9728
v_mfma_f32_16x16x32_bf16 v[184:187], a[12:15], v[196:199], v[184:187]
ds_read_b64_tr_b16 a[184:185], v15 offset:10240
ds_read_b64_tr_b16 a[186:187], v15 offset:10752
v_mfma_f32_16x16x32_bf16 v[180:183], a[16:19], v[200:203], v[180:183]
ds_read_b128 v[192:195], v12 offset:34816
ds_read_b64_tr_b16 a[188:189], v15 offset:11264
v_mfma_f32_16x16x32_bf16 v[184:187], a[20:23], v[200:203], v[184:187]
s_waitcnt lgkmcnt(15)
ds_read_b64_tr_b16 a[190:191], v15 offset:11776
ds_read_b64_tr_b16 a[192:193], v15 offset:12288
v_mfma_f32_16x16x32_bf16 v[180:183], a[24:27], v[204:207], v[180:183]
ds_read_b128 v[196:199], v12 offset:35840
ds_read_b64_tr_b16 a[194:195], v15 offset:12800
v_mfma_f32_16x16x32_bf16 v[184:187], a[28:31], v[204:207], v[184:187]
ds_read_b64_tr_b16 a[196:197], v15 offset:13312
ds_read_b64_tr_b16 a[198:199], v15 offset:13824
v_mfma_f32_16x16x32_bf16 v[180:183], a[32:35], v[208:211], v[180:183]
ds_read_b64_tr_b16 a[200:201], v15 offset:14336
ds_read_b64_tr_b16 a[202:203], v15 offset:14848
ds_read_b64_tr_b16 a[204:205], v15 offset:15360
ds_read_b64_tr_b16 a[206:207], v15 offset:15872
ds_read_b64_tr_b16 a[208:209], v15 offset:16384
ds_read_b64_tr_b16 a[210:211], v15 offset:16896
ds_read_b64_tr_b16 a[212:213], v15 offset:17408
ds_read_b64_tr_b16 a[214:215], v15 offset:17920
ds_read_b128 v[200:203], v232 offset:0
buffer_load_dword v248, v237, s[36:39], 0 offen sc1
v_mfma_f32_16x16x32_bf16 v[184:187], a[36:39], v[208:211], v[184:187]
s_waitcnt lgkmcnt(15)
v_mfma_f32_16x16x32_bf16 v[180:183], a[40:43], v[212:215], v[180:183]
ds_read_b128 v[204:207], v232 offset:1024
v_mfma_f32_16x16x32_bf16 v[184:187], a[44:47], v[212:215], v[184:187]
v_mfma_f32_16x16x32_bf16 v[180:183], a[48:51], v[216:219], v[180:183]
ds_read_b128 v[208:211], v232 offset:2048
v_mfma_f32_16x16x32_bf16 v[184:187], a[52:55], v[216:219], v[184:187]
v_mfma_f32_16x16x32_bf16 v[180:183], a[56:59], v[220:223], v[180:183]
ds_read_b128 v[212:215], v232 offset:3072
v_mfma_f32_16x16x32_bf16 v[184:187], a[60:63], v[220:223], v[184:187]
v_mfma_f32_16x16x32_bf16 v[180:183], a[64:67], v[192:195], v[180:183]
ds_read_b128 v[216:219], v232 offset:4096
v_mfma_f32_16x16x32_bf16 v[184:187], a[68:71], v[192:195], v[184:187]
s_waitcnt lgkmcnt(15)
v_mfma_f32_16x16x32_bf16 v[180:183], a[72:75], v[196:199], v[180:183]
ds_read_b128 v[220:223], v232 offset:5120
v_mfma_f32_16x16x32_bf16 v[184:187], a[76:79], v[196:199], v[184:187]
s_waitcnt lgkmcnt(5)
v_mfma_f32_16x16x32_bf16 v[188:191], a[144:147], v[200:203], 0
s_waitcnt lgkmcnt(4)
ds_read_b128 v[192:195], v232 offset:6144
v_mfma_f32_16x16x32_bf16 v[188:191], a[148:151], v[204:207], v[188:191]
s_waitcnt lgkmcnt(4)
ds_read_b128 v[196:199], v232 offset:7168
v_mfma_f32_16x16x32_bf16 v[188:191], a[152:155], v[208:211], v[188:191]
s_waitcnt lgkmcnt(4)
ds_read_b128 v[200:203], v232 offset:8192
v_mfma_f32_16x16x32_bf16 v[188:191], a[156:159], v[212:215], v[188:191]
s_waitcnt lgkmcnt(4)
ds_read_b128 v[204:207], v232 offset:9216
v_cvt_pk_bf16_f32 v64, v180, v181
v_mfma_f32_16x16x32_bf16 v[188:191], a[160:163], v[216:219], v[188:191]
s_waitcnt lgkmcnt(4)
ds_read_b128 v[208:211], v232 offset:10240
v_cvt_pk_bf16_f32 v65, v182, v183
v_mfma_f32_16x16x32_bf16 v[188:191], a[164:167], v[220:223], v[188:191]
s_waitcnt lgkmcnt(4)
ds_read_b128 v[212:215], v232 offset:11264
v_cvt_pk_bf16_f32 v66, v184, v185
v_mfma_f32_16x16x32_bf16 v[188:191], a[168:171], v[192:195], v[188:191]
s_waitcnt lgkmcnt(4)
ds_read_b128 v[216:219], v232 offset:12288
v_cvt_pk_bf16_f32 v67, v186, v187
v_mfma_f32_16x16x32_bf16 v[188:191], a[172:175], v[196:199], v[188:191]
s_waitcnt lgkmcnt(4)
s_mov_b32 s83, 110592
buffer_store_dwordx4 v[64:67], v234, s[36:39], s83 offen sc1
ds_read_b128 v[220:223], v232 offset:13312
v_mfma_f32_16x16x32_bf16 v[188:191], a[176:179], v[200:203], v[188:191]
s_waitcnt lgkmcnt(4)
ds_read_b128 v[192:195], v232 offset:14336
v_mfma_f32_16x16x32_bf16 v[188:191], a[180:183], v[204:207], v[188:191]
s_waitcnt lgkmcnt(4)
ds_read_b128 v[196:199], v232 offset:15360
v_mfma_f32_16x16x32_bf16 v[188:191], a[184:187], v[208:211], v[188:191]
s_waitcnt lgkmcnt(4)
ds_read_b128 v[200:203], v232 offset:16384
v_mfma_f32_16x16x32_bf16 v[188:191], a[188:191], v[212:215], v[188:191]
s_waitcnt lgkmcnt(4)
ds_read_b128 v[204:207], v232 offset:17408
v_mfma_f32_16x16x32_bf16 v[188:191], a[192:195], v[216:219], v[188:191]
s_waitcnt lgkmcnt(4)
v_mfma_f32_16x16x32_bf16 v[188:191], a[196:199], v[220:223], v[188:191]
s_waitcnt lgkmcnt(3)
v_mfma_f32_16x16x32_bf16 v[188:191], a[200:203], v[192:195], v[188:191]
s_waitcnt lgkmcnt(2)
v_mfma_f32_16x16x32_bf16 v[188:191], a[204:207], v[196:199], v[188:191]
s_waitcnt lgkmcnt(1)
v_mfma_f32_16x16x32_bf16 v[188:191], a[208:211], v[200:203], v[188:191]
s_waitcnt lgkmcnt(0)
v_mfma_f32_16x16x32_bf16 v[188:191], a[212:215], v[204:207], v[188:191]
s_branch L_stream_done
L_rem_1:
buffer_store_dwordx2 v[68:69], v183, s[36:39], 0 offen sc1
buffer_store_dwordx2 v[70:71], v183, s[36:39], s55 offen sc1
s_branch L_bak_2
L_rem_3:
buffer_store_dwordx2 v[72:73], v183, s[36:39], s56 offen sc1
buffer_store_dwordx2 v[74:75], v183, s[36:39], s57 offen sc1
s_branch L_bak_4
L_rem_5:
buffer_store_dword v14, v184, s[36:39], 0 offen sc1
s_branch L_bak_6
L_slow_9:
s_mov_b32 s61, 0x40000
L_sl_11:
buffer_load_dword v248, v239, s[36:39], 0 offen offset:0 sc1
s_sub_u32 s61, s61, 1
s_cbranch_scc1 L_bak_10
s_waitcnt vmcnt(0)
v_cmp_ne_u32 vcc, s49, v248
s_cbranch_vccnz L_sl_11
s_branch L_bak_10
L_slow_17:
s_mov_b32 s61, 0x40000
L_sl_19:
buffer_load_dword v248, v239, s[36:39], 0 offen offset:0 sc1
s_sub_u32 s61, s61, 1
s_cbranch_scc1 L_bak_18
s_waitcnt vmcnt(0)
v_cmp_ne_u32 vcc, s49, v248
s_cbranch_vccnz L_sl_19
s_branch L_bak_18
L_slow_31:
s_mov_b32 s61, 0x40000
L_sl_33:
buffer_load_dword v248, v239, s[36:39], 0 offen offset:0 sc1
s_sub_u32 s61, s61, 1
s_cbranch_scc1 L_bak_32
s_waitcnt vmcnt(0)
v_cmp_ne_u32 vcc, s49, v248
s_cbranch_vccnz L_sl_33
s_branch L_bak_32
L_slow_40:
s_mov_b32 s61, 0x40000
L_sl_42:
buffer_load_dword v249, v238, s[36:39], 0 offen offset:0 sc1
s_sub_u32 s61, s61, 1
s_cbranch_scc1 L_bak_41
s_waitcnt vmcnt(0)
v_cmp_ne_u32 vcc, s49, v249
s_cbranch_vccnz L_sl_42
s_branch L_bak_41
L_slow_43:
s_mov_b32 s61, 0x40000
L_sl_45:
buffer_load_dword v248, v231, s[36:39], 0 offen offset:0 sc1
s_sub_u32 s61, s61, 1
s_cbranch_scc1 L_bak_44
s_waitcnt vmcnt(0)
v_cmp_ne_u32 vcc, s49, v248
s_cbranch_vccnz L_sl_45
s_branch L_bak_44
L_slow_46:
s_mov_b32 s61, 0x40000
L_sl_48:
buffer_load_dword v249, v231, s[36:39], 0 offen offset:128 sc1
s_sub_u32 s61, s61, 1
s_cbranch_scc1 L_bak_47
s_waitcnt vmcnt(0)
v_cmp_ne_u32 vcc, s49, v249
s_cbranch_vccnz L_sl_48
s_branch L_bak_47
L_slow_49:
s_mov_b32 s61, 0x40000
L_sl_51:
buffer_load_dword v250, v231, s[36:39], 0 offen offset:256 sc1
s_sub_u32 s61, s61, 1
s_cbranch_scc1 L_bak_50
s_waitcnt vmcnt(0)
v_cmp_ne_u32 vcc, s49, v250
s_cbranch_vccnz L_sl_51
s_branch L_bak_50
L_slow_52:
s_mov_b32 s61, 0x40000
L_sl_54:
buffer_load_dword v251, v231, s[36:39], 0 offen offset:384 sc1
s_sub_u32 s61, s61, 1
s_cbranch_scc1 L_bak_53
s_waitcnt vmcnt(0)
v_cmp_ne_u32 vcc, s49, v251
s_cbranch_vccnz L_sl_54
s_branch L_bak_53
L_slow_55:
s_mov_b32 s61, 0x40000
L_sl_57:
buffer_load_dword v252, v231, s[36:39], 0 offen offset:512 sc1
s_sub_u32 s61, s61, 1
s_cbranch_scc1 L_bak_56
s_waitcnt vmcnt(0)
v_cmp_ne_u32 vcc, s49, v252
s_cbranch_vccnz L_sl_57
s_branch L_bak_56
L_slow_58:
s_mov_b32 s61, 0x40000
L_sl_60:
buffer_load_dword v248, v231, s[36:39], 0 offen offset:0 sc1
s_sub_u32 s61, s61, 1
s_cbranch_scc1 L_bak_59
s_waitcnt vmcnt(0)
v_cmp_ne_u32 vcc, s49, v248
s_cbranch_vccnz L_sl_60
s_branch L_bak_59
L_slow_61:
s_mov_b32 s61, 0x40000
L_sl_63:
buffer_load_dword v249, v231, s[36:39], 0 offen offset:128 sc1
s_sub_u32 s61, s61, 1
s_cbranch_scc1 L_bak_62
s_waitcnt vmcnt(0)
v_cmp_ne_u32 vcc, s49, v249
s_cbranch_vccnz L_sl_63
s_branch L_bak_62
L_slow_64:
s_mov_b32 s61, 0x40000
L_sl_66:
buffer_load_dword v250, v231, s[36:39], 0 offen offset:256 sc1
s_sub_u32 s61, s61, 1
s_cbranch_scc1 L_bak_65
s_waitcnt vmcnt(0)
v_cmp_ne_u32 vcc, s49, v250
s_cbranch_vccnz L_sl_66
s_branch L_bak_65
L_slow_67:
s_mov_b32 s61, 0x40000
L_sl_69:
buffer_load_dword v251, v231, s[36:39], 0 offen offset:384 sc1
s_sub_u32 s61, s61, 1
s_cbranch_scc1 L_bak_68
s_waitcnt vmcnt(0)
v_cmp_ne_u32 vcc, s49, v251
s_cbranch_vccnz L_sl_69
s_branch L_bak_68
L_slow_70:
s_mov_b32 s61, 0x40000
L_sl_72:
buffer_load_dword v252, v231, s[36:39], 0 offen offset:512 sc1
s_sub_u32 s61, s61, 1
s_cbranch_scc1 L_bak_71
s_waitcnt vmcnt(0)
v_cmp_ne_u32 vcc, s49, v252
s_cbranch_vccnz L_sl_72
s_branch L_bak_71
L_slow_74:
s_mov_b32 s61, 0x40000
L_sl_76:
buffer_load_dword v248, v237, s[36:39], 0 offen offset:0 sc1
s_sub_u32 s61, s61, 1
s_cbranch_scc1 L_bak_75
s_waitcnt vmcnt(0)
v_cmp_ne_u32 vcc, s49, v248
s_cbranch_vccnz L_sl_76
s_branch L_bak_75
.fill 1024, 4, 0xbf800000
.section .rodata,"a"
.p2align 6
.amdhsa_kernel standalone__mixer_s_mlp__sampling_kernel
  .amdhsa_next_free_vgpr 512
  .amdhsa_next_free_sgpr 102
  .amdhsa_accum_offset 256
  .amdhsa_group_segment_fixed_size 0
  .amdhsa_kernarg_size 64
  .amdhsa_user_sgpr_count 2
  .amdhsa_user_sgpr_kernarg_segment_ptr 1
  .amdhsa_system_sgpr_workgroup_id_x 1
  .amdhsa_float_denorm_mode_32 3
  .amdhsa_float_denorm_mode_16_64 3
.end_amdhsa_kernel
.text
```
